```python
import torch

def _softmax(x, axis=-1):
    return torch.softmax(x, dim=axis)
def _gelu(x):
    return torch.nn.functional.gelu(x, approximate="tanh")
def _silu(x):
    return torch.nn.functional.silu(x)
def _sigmoid(x):
    return torch.sigmoid(x)
def _layernorm(x, axis=-1, eps=1e-5):
    m = x.mean(dim=axis, keepdim=True)
    v = x.var(dim=axis, keepdim=True, unbiased=False)
    return (x - m) / torch.sqrt(v + eps)
def _scatter_add(tgt, idx, src, axis=0):
    return tgt.clone().index_add_(axis, idx, src)
def _segment_sum(src, seg, n):
    out = torch.zeros((n,) + src.shape[1:], dtype=src.dtype)
    return out.index_add_(0, seg, src)
def _pad(x, pw):
    flat = tuple(v for pair in reversed(pw) for v in pair)
    return torch.nn.functional.pad(x, flat)

kernel_name = 'gated_mix__linear_attn_block__ssm_conv_s5__prompt'

def setup_inputs():

    _w = (lambda a: (lambda t: t.to(torch.bfloat16) if t.is_floating_point() else t)(torch.as_tensor(a)))
    def _A_setup():
        B, S, D = 1, 2048, 512
        return {
            "x": _w((lambda *s: torch.randn(*s, dtype=torch.bfloat16) * 0.05)(B, S, D)),
            "wqkv": _w((lambda *s: torch.randn(*s, dtype=torch.bfloat16) * 0.8)(D, 3 * D)),
            "wo": _w((lambda *s: torch.randn(*s, dtype=torch.bfloat16) * 0.05)(D, D)),
        }
    _A_in = _A_setup()

    def _B_setup():
        B, S, D = 1, 2048, 512
        P = D
        Lambda_re = -0.5 * (lambda _x: torch.exp(torch.as_tensor(_x)))((lambda *s: torch.randn(*s, dtype=torch.bfloat16) * 0.2)(P))
        Lambda_im = (lambda *s: torch.randn(*s, dtype=torch.bfloat16) * 0.8)(P) * 1.0
        B_re = (lambda *s: torch.randn(*s, dtype=torch.bfloat16) * 0.4)(P, D) * (D ** -0.5)
        B_im = (lambda *s: torch.randn(*s, dtype=torch.bfloat16) * 0.4)(P, D) * (D ** -0.5)
        C_re = (lambda *s: torch.randn(*s, dtype=torch.bfloat16) * 0.4)(D, P) * (P ** -0.5)
        C_im = (lambda *s: torch.randn(*s, dtype=torch.bfloat16) * 0.4)(D, P) * (P ** -0.5)
        log_dt = (lambda *s: torch.randn(*s, dtype=torch.bfloat16) * 0.2)(P) * 0.3 - 2.0
        Dskip = (lambda *s: torch.randn(*s, dtype=torch.bfloat16) * 0.05)(D)
        return {
            "x": _w((lambda *s: torch.randn(*s, dtype=torch.bfloat16) * 0.05)(B, S, D)),
            "Lambda_re": _w(Lambda_re),
            "Lambda_im": _w(Lambda_im),
            "B_re": _w(B_re),
            "B_im": _w(B_im),
            "C_re": _w(C_re),
            "C_im": _w(C_im),
            "log_dt": _w(log_dt),
            "Dskip": _w(Dskip),
        }
    _B_in = _B_setup()

    return {
        "A_x": _A_in["x"],
        "A_wqkv": _A_in["wqkv"],
        "A_wo": _A_in["wo"],
        "B_x": _B_in["x"],
        "B_Lambda_re": _B_in["Lambda_re"],
        "B_Lambda_im": _B_in["Lambda_im"],
        "B_B_re": _B_in["B_re"],
        "B_B_im": _B_in["B_im"],
        "B_C_re": _B_in["C_re"],
        "B_C_im": _B_in["C_im"],
        "B_log_dt": _B_in["log_dt"],
        "B_Dskip": _B_in["Dskip"],
        "gate_w": _w((lambda *s: torch.randn(*s, dtype=torch.bfloat16) * 0.05)(512) * 16.0),
    }

def reference(A_x, A_wqkv, A_wo, B_x, B_Lambda_re, B_Lambda_im, B_B_re, B_B_im, B_C_re, B_C_im, B_log_dt, B_Dskip, gate_w):
    def _A_ref(x, wqkv, wo):
        B, S, D = x.shape
        H = 32; Dh = D // H
        qkv = (lambda x, *d: x.permute(*d))((x @ wqkv).reshape(B, S, 3, H, Dh), 2, 0, 3, 1, 4)
        q, k, v = qkv[0], qkv[1], qkv[2]
        phi = lambda t: torch.where(t > 0, t + 1, torch.exp(t)) + 1e-6
        pq, pk = phi(q), phi(k)
        kv = torch.einsum("bhsd,bhse->bhde", pk, v)
        z = torch.einsum("bhsd->bhd", pk)
        num = torch.einsum("bhqd,bhde->bhqe", pq, kv)
        den = torch.einsum("bhqd,bhd->bhq", pq, z)[..., None] + 1e-6
        o = num / den
        return (lambda x, *d: x.permute(*d))(o, 0, 2, 1, 3).reshape(B, S, D) @ wo

    def _B_ref(x, Lambda_re, Lambda_im, B_re, B_im, C_re, C_im, log_dt, Dskip):
        Bsz, L, H = x.shape
        Lam = Lambda_re + 1j * Lambda_im
        Bmat = B_re + 1j * B_im
        Cmat = C_re + 1j * C_im
        dt = torch.exp(log_dt)
        Lam_bar = torch.exp(dt * Lam)
        B_bar = ((Lam_bar - 1.0) / Lam)[:, None] * Bmat
        Bu = torch.einsum("bld,pd->blp", x + 0j, B_bar)
        h = torch.zeros_like(Bu[:, 0, :])
        hs = []
        for t in range(L):
            h = Lam_bar[None, :] * h + Bu[:, t, :]
            hs.append(h)
        hseq = torch.stack(hs, 1)
        y = 2.0 * torch.einsum("blp,dp->bld", hseq, Cmat).real + x * Dskip[None, None, :]
        return y

    x = A_x
    g = _sigmoid((x * gate_w).sum(-1, keepdims=True))
    a = _A_ref(x, A_wqkv, A_wo)
    b = _B_ref(x, B_Lambda_re, B_Lambda_im, B_B_re, B_B_im, B_C_re, B_C_im, B_log_dt, B_Dskip)
    return g * a + (1 - g) * b
```

```asm
; @launch grid=(256,1,1) block=(256,1,1) lds=163840
.amdgcn_target "amdgcn-amd-amdhsa--gfx950"
.text
.globl gated_mix__linear_attn_block__ssm_conv_s5__prompt_kernel
.p2align 8
.type gated_mix__linear_attn_block__ssm_conv_s5__prompt_kernel,@function
gated_mix__linear_attn_block__ssm_conv_s5__prompt_kernel:
    s_cmp_ge_u32 s2, 256
    s_cbranch_scc1 L_end
    s_load_dwordx16 s[36:51], s[0:1], 0
    s_load_dwordx16 s[52:67], s[0:1], 64
    s_getpc_b64 s[96:97]
L_pc:
    s_mov_b32 s98, L_codeend-L_pc
    s_mov_b32 s99, 0x20000
    s_bfe_u32 s3, s2, 0x40003
    v_lshl_add_u32 v1, v0, 4, s3
    v_lshlrev_b32_e64 v1, 7, v1
    buffer_load_dword v254, v1, s[96:99], 0 offen
    v_lshrrev_b32 v1, 6, v0
    v_and_b32_e64 v0, 63, v0
    v_readfirstlane_b32 s71, v1
    s_lshr_b32 s77, s2, 3
    s_and_b32 s78, s2, 1
    s_and_b32 s76, s77, 7
    s_lshl3_add_u32 s68, s78, s76
    s_and_b32 s69, s2, 6
    s_lshr_b32 s78, s2, 7
    s_add_u32 s69, s69, s78
    s_lshr_b32 s78, s77, 3
    s_add_u32 s86, s78, s68
    s_bitcmp1_b32 s86, 0
    s_mov_b32 s3, 0x76532140
    s_cselect_b32 s3, 0x76432501, s3
    s_mov_b32 s81, 0x75416032
    s_cselect_b32 s81, 0x65470123, s81
    s_bitcmp1_b32 s86, 1
    s_cselect_b32 s3, s81, s3
    s_and_b32 s81, s3, 7
    s_lshl_b32 s81, s81, 7
    s_lshr_b32 s72, s71, 1
    s_and_b32 s73, s71, 1
    s_lshl_b32 s83, s71, 12
    v_lshrrev_b32 v1, 5, v0
    v_lshrrev_b32 v5, 4, v0
    v_and_b32 v2, 15, v0
    v_and_b32 v6, 7, v0
    v_xor_b32 v4, v6, v5
    v_lshlrev_b32_e64 v4, 4, v4
    v_bfe_u32 v7, v0, 4, 1
    v_lshlrev_b32 v7, 1, v7
    v_xor_b32 v9, v6, v7
    v_lshlrev_b32 v9, 4, v9
    s_lshl2_add_u32 s79, s68, s71
    s_lshl_b32 s79, s79, 15
    s_lshl_b32 s77, s71, 1
    v_xor_b32_e64 v6, s77, v6
    v_lshl_add_u32 v7, v6, 4, s79
    v_lshrrev_b32_e64 v6, 3, v0
    v_lshl_add_u32 v10, v6, 10, v7
    v_add_u32 v11, 7168, v10
    v_xor_b32_e64 v7, 16, v10
    v_add_u32 v12, 14336, v7
    v_add_u32 v13, 21504, v7
    s_mul_i32 s77, s73, 96
    s_add_u32 s77, s77, s72
    s_add_u32 s77, s77, 1
    s_lshl3_add_u32 s77, s77, s69
    s_lshl_b32 s77, s77, 7
    s_lshl1_add_u32 s78, s69, s72
    s_lshl_b32 s78, s78, 15
    s_bitcmp1_b32 s2, 6
    s_cselect_b32 s70, 1, 0
    s_cselect_b32 s77, s77, s78
    s_cselect_b32 s82, 1536, 1
    s_cselect_b32 s78, 3, 1
    s_cselect_b32 s79, 23, 7
    s_cselect_b64 vcc, -1, 0
    s_lshl_b32 s10, s78, 19
    s_lshl_b32 s78, s78, 10
    s_lshl_b32 s79, s79, 10
    v_mul_u32_u24 v6, s78, v6
    v_cndmask_b32_e64 v7, v4, v9, vcc
    v_add3_u32 v14, v6, s77, v7
    v_xor_b32 v15, 64, v14
    v_add_u32 v15, s79, v15
    v_lshl_add_u32 v16, s79, 1, v14
    v_lshl_add_u32 v17, s79, 1, v15
    s_lshl2_add_u32 s84, s69, s71
    s_lshl_b32 s77, s84, 5
    v_lshl_add_u32 v8, v2, 1, s77
    s_mov_b32 s6, 0x200000
    s_mov_b32 s7, 0x20000
    s_mov_b32 s11, 0x20000
    s_waitcnt lgkmcnt(0)
    s_mov_b64 s[4:5], s[36:37]
    s_and_b32 s42, s86, 0
    s_and_b32 s43, s86, 3
    s_cbranch_vccnz L_nolam
    global_load_ushort v192, v8, s[44:45]
    global_load_ushort v193, v8, s[46:47]
    global_load_ushort v194, v8, s[56:57]
L_nolam:
    s_add_u32 m0, s83, 32768
    s_nop 0
    buffer_load_dwordx4 v10, s[4:7], s81 offen lds
    buffer_load_dwordx4 v11, s[4:7], s81 offen offset:1024 lds
    buffer_load_dwordx4 v12, s[4:7], s81 offen offset:2048 lds
    buffer_load_dwordx4 v13, s[4:7], s81 offen offset:3072 lds
    s_cmp_eq_u32 s73, 0
    s_cselect_b64 s[8:9], s[48:49], s[50:51]
    s_cmp_eq_u32 s70, 1
    s_cselect_b64 s[8:9], s[38:39], s[8:9]
    s_add_u32 m0, s83, 49152
    s_mul_i32 s80, s81, s82
    buffer_load_dwordx4 v14, s[8:11], s80 offen lds
    buffer_load_dwordx4 v15, s[8:11], s80 offen offset:1024 lds
    buffer_load_dwordx4 v16, s[8:11], s80 offen offset:2048 lds
    buffer_load_dwordx4 v17, s[8:11], s80 offen offset:3072 lds
    s_and_b32 s75, s2, 1
    s_bfe_u32 s78, s2, 0x20001
    s_lshl2_add_u32 s75, s75, s78
    s_lshr_b32 s78, s2, 6
    s_lshl2_add_u32 s75, s75, s78
    s_and_b32 s78, s76, 1
    s_xor_b32 s75, s75, s78
    v_lshlrev_b32 v3, 4, v0
    v_mov_b32 v34, 0
    v_lshrrev_b32 v6, 2, v2
    v_and_b32_e64 v7, 1, v2
    v_lshl_add_u32 v6, v6, 1, v7
    v_xor_b32 v7, v6, v5
    v_lshlrev_b32 v7, 4, v7
    v_lshl_add_u32 v6, v6, 11, v7
    v_bfe_u32 v7, v2, 1, 1
    v_lshl_add_u32 v6, v7, 7, v6
    s_mul_i32 s77, s72, s70
    s_lshl_b32 s77, s77, 10
    s_add_u32 s77, s77, 32768
    v_add_u32 v18, s77, v6
    v_xor_b32 v19, 64, v18
    v_add_u32 v20, 0x10000, v18
    v_add_u32 v21, 0x10000, v19
    s_mov_b64 s[12:13], s[66:67]
    s_mov_b32 s14, 0x6b0000
    s_mov_b32 s15, 0x20000
    s_mul_i32 s85, s69, 49152
    s_add_u32 s85, s85, 6291456
    s_mov_b64 s[16:17], s[62:63]
    s_mov_b32 s18, 0x400000
    s_mov_b32 s19, 0x20000
    s_mov_b64 s[20:21], s[40:41]
    s_mov_b32 s22, 0x80000
    s_mov_b32 s23, 0x20000
    s_cmp_eq_u32 s73, 0
    s_cselect_b64 s[24:25], s[52:53], s[54:55]
    s_mov_b32 s26, 0x80000
    s_mov_b32 s27, 0x20000
    s_lshr_b32 s78, s69, 2
    s_lshl3_add_u32 s78, s68, s78
    s_mul_i32 s87, s78, 49152
    s_lshl3_add_u32 s77, s75, s76
    s_lshl_b32 s77, s77, 7
    s_add_u32 s77, s77, 6684672
    s_add_u32 s48, s66, s77
    s_addc_u32 s49, s67, 0
    s_lshl2_add_u32 s77, s68, s71
    s_lshl_b32 s77, s77, 9
    s_add_u32 s77, s77, 6684672
    s_add_u32 s50, s66, s77
    s_addc_u32 s51, s67, 0
    v_and_b32 v7, 1, v2
    v_lshlrev_b32_e64 v7, 4, v7
    v_mov_b32 v136, 0x3f80
    v_lshlrev_b32 v7, v7, v136
    v_lshrrev_b32 v6, 1, v2
    v_lshlrev_b32 v136, 1, v5
    v_sub_u32 v6, v6, v136
    v_cmp_eq_u32_e64 vcc, 0, v6
    v_cmp_eq_u32 s[92:93], 1, v6
    s_nop 0
    v_cndmask_b32 v136, 0, v7, vcc
    v_cndmask_b32 v137, 0, v7, s[92:93]
    v_lshrrev_b32_e64 v6, 3, v0
    v_mul_u32_u24 v6, 1024, v6
    s_lshl_b32 s77, s76, 16
    v_add3_u32 v248, v6, s77, v4
    v_xor_b32 v249, 64, v248
    v_add_u32 v249, 7168, v249
    v_add_u32 v250, 14336, v248
    v_add_u32 v251, 14336, v249
    v_bfe_u32 v6, v0, 3, 1
    v_bfe_u32 v7, v0, 4, 1
    v_lshl_add_u32 v6, v6, 3, v7
    v_lshl_add_u32 v6, v1, 4, v6
    v_and_b32 v7, 0x70, v3
    v_lshl_add_u32 v138, v6, 11, v7
    v_and_b32 v6, 31, v0
    v_lshlrev_b32_e64 v139, 2, v6
    s_lshr_b32 s52, s75, 1
    s_mul_i32 s52, s52, 14
    s_add_u32 s52, s52, s75
    s_lshl1_add_u32 s52, s52, s72
    s_lshl2_add_u32 s52, s52, s73
    s_lshl3_add_u32 s52, s52, s76
    s_mov_b64 s[28:29], s[58:59]
    s_mov_b32 s30, 0x400
    s_mov_b32 s31, 0x20000
    s_lshl1_add_u32 s77, s75, s72
    s_lshl_b32 s47, s77, 7
    s_add_u32 s47, s47, 6815744
    s_lshl2_add_u32 s77, s75, s71
    s_mul_i32 s46, s77, 49152
    s_lshl_b32 s44, s42, 13
    s_lshl_b32 s45, s42, 12
    s_lshl_b32 s53, s83, 1
    s_lshl3_add_u32 s54, s73, s53
    s_lshl_b32 s77, s72, 5
    s_add_u32 s77, s77, s73
    s_lshl_b32 s55, s77, 9
    s_lshl_b32 s58, s73, 15
    s_add_u32 s58, s58, 32768
    s_cmp_eq_u32 s70, 1
    s_cbranch_scc1 L_roleA
    s_mov_b64 s[94:95], s[60:61]
    s_lshl_b32 s79, s71, 3
    v_lshl_add_u32 v6, v1, 2, s79
    v_bfe_u32 v6, s3, v6, 3
    v_lshl_add_u32 v253, v6, 7, v139
    s_mov_b32 s35, 0x20000
    s_mov_b32 s90, 0
    s_lshl_b32 s60, 1, s69
    s_lshl_b32 s59, s73, 2
    s_lshl_b32 s61, 0xf00, s59
    s_or_b32 s61, s61, 0xff
    s_mov_b32 s91, -1
    s_mov_b32 s88, 0xffff0000
    s_mov_b32 s89, 0xffff0000
    v_lshrrev_b32 v6, 1, v2
    v_xor_b32 v6, v6, v5
    v_lshlrev_b32 v6, 4, v6
    v_lshl_add_u32 v6, v2, 7, v6
    s_lshl2_add_u32 s77, s72, s73
    s_lshl_b32 s77, s77, 11
    s_add_u32 s77, s77, 49152
    v_add_u32 v22, s77, v6
    v_xor_b32 v23, 64, v22
    v_add_u32 v24, 0x10000, v22
    v_add_u32 v25, 0x10000, v23
    v_and_b32_e64 v6, 1, v5
    v_lshl_add_u32 v6, s71, 1, v6
    v_lshlrev_b32 v7, 1, v6
    v_xor_b32 v7, v7, v2
    v_lshlrev_b32_e64 v7, 3, v7
    v_lshl_add_u32 v6, v6, 11, v7
    v_lshl_add_u32 v6, v1, 7, v6
    s_lshl_b32 s77, s69, 8
    s_add_u32 s77, s77, 32768
    v_add_u32 v36, s77, v6
    v_add_u32 v37, 0x10000, v36
    v_and_b32_e64 v6, 3, v5
    v_and_b32 v7, 0x70, v3
    v_lshlrev_b32 v6, 5, v6
    v_xor_b32 v7, v6, v7
    v_lshrrev_b32_e64 v6, 3, v0
    v_mul_u32_u24 v6, 1024, v6
    s_xor_b32 s77, s71, s42
    s_lshl_b32 s77, s77, 16
    s_lshl_b32 s78, s76, 7
    s_add_u32 s77, s77, s78
    v_add3_u32 v228, v6, s77, v7
    v_add_u32 v229, 7168, v228
    v_add_u32 v230, 14336, v228
    v_add_u32 v231, 14336, v229
    v_bfe_u32 v6, v0, 2, 2
    v_mad_u32_u24 v6, v5, 4, v6
    v_lshlrev_b32 v26, 7, v6
    v_and_b32 v6, 3, v0
    v_lshl_add_u32 v26, v6, 3, v26
    v_bfe_u32 v6, v0, 3, 2
    v_lshl_add_u32 v26, v6, 5, v26
    s_lshl_b32 s77, s73, 15
    s_add_u32 s77, s77, 98304
    v_add_u32 v26, s77, v26
    v_xor_b32 v27, 32, v26
    v_xor_b32 v28, 64, v26
    v_xor_b32 v29, 96, v26
    s_lshl2_add_u32 s77, s68, s71
    s_lshl_b32 s77, s77, 7
    v_lshl_add_u32 v35, v2, 3, s77
    v_lshlrev_b32 v6, 9, v5
    v_sub_u32 v220, v35, v6
    v_subrev_u32 v220, 512, v220
    v_subrev_u32 v221, 2048, v220
    v_subrev_u32 v222, 4096, v220
    v_subrev_u32 v223, 6144, v220
    v_lshl_or_b32 v35, v5, 28, v35
    s_add_u32 s32, s66, s85
    s_addc_u32 s33, s67, 0
    s_add_u32 s32, s32, 34816
    s_addc_u32 s33, s33, 0
    s_mov_b32 s34, 8192
    s_and_b32 s77, s84, 15
    s_lshl_b32 s77, s77, 11
    s_add_u32 s87, s87, s77
    s_mov_b64 s[96:97], s[38:39]
    s_and_b32 s77, s68, 7
    s_lshl2_add_u32 s77, s77, s71
    s_mul_i32 s77, s77, 384
    s_add_u32 s77, s77, s69
    s_lshl_b32 s77, s77, 7
    v_mul_u32_u24 v252, 3072, v0
    v_lshl_or_b32 v252, v5, 28, v252
    v_add_u32 v252, s77, v252
    s_waitcnt vmcnt(10)
    v_lshlrev_b32 v192, 16, v192
    s_waitcnt vmcnt(9)
    v_lshlrev_b32 v193, 16, v193
    s_waitcnt vmcnt(8)
    v_lshlrev_b32 v194, 16, v194
    v_mul_f32 v194, 0x3fb8aa3b, v194
    v_exp_f32 v194, v194
    s_nop 0
    v_cvt_pk_bf16_f32 v194, v194, v194
    v_lshlrev_b32 v194, 16, v194
    v_mul_f32 v218, v194, v192
    v_mul_f32_e64 v219, v194, v193
    v_mul_f32 v218, 0x3fb8aa3b, v218
    v_mul_f32 v219, 0.15915494, v219
    v_exp_f32 v218, v218
    v_rndne_f32 v194, v219
    v_sub_f32 v219, v219, v194
    v_cos_f32 v144, v219
    v_sin_f32 v145, v219
    v_mul_f32 v144, v144, v218
    v_mul_f32 v145, v145, v218
    v_mul_f32 v194, v192, v192
    v_fmac_f32 v194, v193, v193
    v_rcp_f32 v194, v194
    v_add_f32 v218, -1.0, v144
    v_sub_f32 v195, 0, v145
    v_add_f32 v194, v194, v194
    v_mul_f32 v196, v218, v192
    v_mul_f32 v197, v145, v192
    v_fmac_f32_e64 v196, v145, v193
    v_fma_f32 v197, -v218, v193, v197
    v_mul_f32 v196, v196, v194
    v_mul_f32 v197, v197, v194
    v_mul_f32 v146, v144, v144
    v_mul_f32 v147, v144, v145
    v_fma_f32 v146, -v145, v145, v146
    v_fmac_f32 v147, v145, v144
    v_mul_f32 v148, v146, v146
    v_mul_f32_e64 v149, v146, v147
    v_fma_f32 v148, -v147, v147, v148
    v_fmac_f32 v149, v147, v146
    v_mul_f32 v150, v148, v148
    v_mul_f32_e64 v151, v148, v149
    v_fma_f32 v150, -v149, v149, v150
    v_fmac_f32 v151, v149, v148
    v_mul_f32 v200, v150, v150
    v_mul_f32_e64 v201, v150, v151
    v_fma_f32 v200, -v151, v151, v200
    v_fmac_f32 v201, v151, v150
    v_mul_f32 v202, v200, v200
    v_mul_f32_e64 v203, v200, v201
    v_fma_f32 v202, -v201, v201, v202
    v_fmac_f32 v203, v201, v200
    v_mul_f32 v204, v202, v202
    v_mul_f32_e64 v205, v202, v203
    v_fma_f32 v204, -v203, v203, v204
    v_fmac_f32 v205, v203, v202
    v_mul_f32 v206, v204, v204
    v_mul_f32_e64 v207, v204, v205
    v_fma_f32 v206, -v205, v205, v206
    v_fmac_f32 v207, v205, v204
    v_mul_f32 v208, v206, v206
    v_mul_f32_e64 v209, v206, v207
    v_fma_f32 v208, -v207, v207, v208
    v_fmac_f32 v209, v207, v206
    v_mul_f32 v210, v208, v208
    v_mul_f32_e64 v211, v208, v209
    v_fma_f32 v210, -v209, v209, v210
    v_fmac_f32_e64 v211, v209, v208
    v_cndmask_b32 v188, v202, 1.0, s[88:89]
    v_cndmask_b32 v189, v203, 0, s[88:89]
    v_cndmask_b32 v190, v204, 1.0, s[90:91]
    v_cndmask_b32 v191, v205, 0, s[90:91]
    v_mul_f32 v184, v188, v190
    v_mul_f32 v185, v188, v191
    v_fma_f32 v184, -v189, v191, v184
    v_fmac_f32_e64 v185, v189, v190
    v_cndmask_b32 v188, 1.0, v202, s[88:89]
    v_cndmask_b32 v189, 0, v203, s[88:89]
    v_cndmask_b32 v190, 1.0, v204, s[90:91]
    v_cndmask_b32 v191, 0, v205, s[90:91]
    v_mul_f32 v186, v188, v190
    v_mul_f32 v187, v188, v191
    v_fma_f32 v186, -v189, v191, v186
    v_fmac_f32 v187, v189, v190
    v_mul_f32 v212, v196, v186
    v_mul_f32_e64 v213, v196, v187
    v_fma_f32 v212, -v197, v187, v212
    v_fmac_f32 v213, v197, v186
    v_mul_f32 v214, v212, v200
    v_mul_f32_e64 v215, v212, v201
    v_fma_f32 v214, -v213, v201, v214
    v_fmac_f32_e64 v215, v213, v200
    s_add_u32 m0, s83, 65536
    s_bfe_u32 s81, s3, 0x30004
    s_lshl_b32 s81, s81, 7
    s_nop 0
    buffer_load_dwordx4 v10, s[4:7], s81 offen lds
    buffer_load_dwordx4 v11, s[4:7], s81 offen offset:1024 lds
    v_cndmask_b32 v188, 1.0, v206, s[88:89]
    v_cndmask_b32 v189, 0, v207, s[88:89]
    v_cndmask_b32 v190, 1.0, v208, s[90:91]
    v_cndmask_b32 v191, 0, v209, s[90:91]
    v_mul_f32 v176, v188, v190
    v_mul_f32 v177, v188, v191
    v_fma_f32 v176, -v189, v191, v176
    v_fmac_f32 v177, v189, v190
    v_mul_f32 v178, v176, v210
    v_mul_f32_e64 v179, v176, v211
    buffer_load_dwordx4 v12, s[4:7], s81 offen offset:2048 lds
    buffer_load_dwordx4 v13, s[4:7], s81 offen offset:3072 lds
    v_fma_f32 v178, -v177, v211, v178
    v_fmac_f32 v179, v177, v210
    v_mul_f32 v180, v178, v210
    v_mul_f32_e64 v181, v178, v211
    v_fma_f32 v180, -v179, v211, v180
    v_fmac_f32 v181, v179, v210
    v_mul_f32 v182, v180, v210
    v_mul_f32_e64 v183, v180, v211
    v_fma_f32 v182, -v181, v211, v182
    v_fmac_f32_e64 v183, v181, v210
    s_add_u32 m0, s83, 81920
    s_mul_i32 s80, s81, s82
    buffer_load_dwordx4 v14, s[8:11], s80 offen lds
    buffer_load_dwordx4 v15, s[8:11], s80 offen offset:1024 lds
    buffer_load_dwordx4 v16, s[8:11], s80 offen offset:2048 lds
    buffer_load_dwordx4 v17, s[8:11], s80 offen offset:3072 lds
    s_bitcmp1_b32 1, s43
    s_cselect_b32 s98, 0x180000, 0
    buffer_load_dword v254, v252, s[96:99], 0 offen
    s_cmp_ge_u32 s68, 12
    s_cbranch_scc0 L_nolead
    v_mov_b32 v240, -1
    v_mov_b32 v241, -1
    v_mov_b32 v242, -1
    v_mov_b32 v243, -1
    v_lshl_or_b32 v9, v5, 26, v3
    s_and_b32 s77, s68, 3
    s_lshl2_add_u32 s79, s77, s71
    s_mul_i32 s79, s79, 3072
    s_add_u32 s79, s79, s85
    buffer_store_dwordx4 v[240:243], v3, s[12:15], s79 offen offset:0 sc1
    buffer_store_dwordx4 v[240:243], v3, s[12:15], s79 offen offset:1024 sc1
    buffer_store_dwordx4 v[240:243], v3, s[12:15], s79 offen offset:2048 sc1
    s_lshl2_add_u32 s79, s69, s77
    s_lshl2_add_u32 s79, s79, s71
    s_lshl_b32 s79, s79, 8
    s_add_u32 s79, s79, 6684672
    buffer_store_dwordx4 v[240:243], v9, s[12:15], s79 offen sc1
L_nolead:
    s_cmp_ge_u32 s68, 12
    s_cbranch_scc1 L_lw0
    s_waitcnt vmcnt(9)
L_lw0:
    s_waitcnt vmcnt(13)
    s_barrier
    s_nop 0
    ds_read_b128 a[0:3], v18 offset:0
    ds_read_b128 v[40:43], v22 offset:0
    ds_read_b128 a[4:7], v19 offset:0
    ds_read_b128 v[44:47], v23 offset:0
    ds_read_b128 v[48:51], v22 offset:4096
    ds_read_b128 v[52:55], v23 offset:4096
    ds_read_b128 a[8:11], v18 offset:256
    ds_read_b128 a[12:15], v19 offset:256
    s_waitcnt lgkmcnt(6)
    v_mfma_f32_16x16x32_bf16 v[72:75], a[0:3], v[40:43], 0
    ds_read_b128 a[16:19], v18 offset:512
    s_add_u32 m0, s83, 98304
    s_bfe_u32 s81, s3, 0x30008
    s_lshl_b32 s81, s81, 7
    buffer_load_dwordx4 v10, s[4:7], s81 offen lds
    s_waitcnt lgkmcnt(5)
    v_mfma_f32_16x16x32_bf16 v[72:75], a[4:7], v[44:47], v[72:75]
    ds_read_b128 a[20:23], v19 offset:512
    ds_read_b128 a[24:27], v18 offset:768
    s_waitcnt lgkmcnt(6)
    v_mfma_f32_16x16x32_bf16 v[104:107], a[0:3], v[48:51], 0
    ds_read_b128 a[28:31], v19 offset:768
    buffer_load_dwordx4 v11, s[4:7], s81 offen offset:1024 lds
    s_waitcnt lgkmcnt(6)
    v_mfma_f32_16x16x32_bf16 v[104:107], a[4:7], v[52:55], v[104:107]
    ds_read_b128 a[32:35], v18 offset:1024
    s_waitcnt lgkmcnt(6)
    v_mfma_f32_16x16x32_bf16 v[76:79], a[8:11], v[40:43], 0
    ds_read_b128 a[36:39], v19 offset:1024
    buffer_load_dwordx4 v12, s[4:7], s81 offen offset:2048 lds
    s_waitcnt lgkmcnt(6)
    s_nop 0
    v_mfma_f32_16x16x32_bf16 v[76:79], a[12:15], v[44:47], v[76:79]
    ds_read_b64 v[232:233], v36 offset:0
    v_mfma_f32_16x16x32_bf16 v[108:111], a[8:11], v[48:51], 0
    ds_read_b128 a[40:43], v18 offset:1280
    buffer_load_dwordx4 v13, s[4:7], s81 offen offset:3072 lds
    v_mfma_f32_16x16x32_bf16 v[108:111], a[12:15], v[52:55], v[108:111]
    ds_read_b128 a[44:47], v19 offset:1280
    s_add_u32 m0, s83, 114688
    s_waitcnt lgkmcnt(8)
    v_mfma_f32_16x16x32_bf16 v[80:83], a[16:19], v[40:43], 0
    ds_read_b128 a[48:51], v18 offset:1536
    s_mul_i32 s80, s81, s82
    buffer_load_dwordx4 v14, s[8:11], s80 offen lds
    s_waitcnt lgkmcnt(8)
    s_nop 0
    v_mfma_f32_16x16x32_bf16 v[80:83], a[20:23], v[44:47], v[80:83]
    ds_read_b128 a[52:55], v19 offset:1536
    v_mfma_f32_16x16x32_bf16 v[112:115], a[16:19], v[48:51], 0
    buffer_load_dwordx4 v15, s[8:11], s80 offen offset:1024 lds
    v_mfma_f32_16x16x32_bf16 v[112:115], a[20:23], v[52:55], v[112:115]
    s_waitcnt lgkmcnt(8)
    v_mfma_f32_16x16x32_bf16 v[84:87], a[24:27], v[40:43], 0
    ds_read_b128 a[56:59], v18 offset:1792
    buffer_load_dwordx4 v16, s[8:11], s80 offen offset:2048 lds
    s_waitcnt lgkmcnt(8)
    v_mfma_f32_16x16x32_bf16 v[84:87], a[28:31], v[44:47], v[84:87]
    ds_read_b128 a[60:63], v19 offset:1792
    v_mfma_f32_16x16x32_bf16 v[116:119], a[24:27], v[48:51], 0
    buffer_load_dwordx4 v17, s[8:11], s80 offen offset:3072 lds
    v_mfma_f32_16x16x32_bf16 v[116:119], a[28:31], v[52:55], v[116:119]
    s_waitcnt lgkmcnt(6)
    v_mfma_f32_16x16x32_bf16 v[88:91], a[32:35], v[40:43], 0
    s_bitcmp1_b32 2, s43
    s_cselect_b32 s98, 0x180000, 0
    buffer_load_dword v254, v252, s[96:99], 0 offen
    s_cmp_ge_u32 s68, 12
    s_cbranch_scc1 L_lw1
    s_waitcnt vmcnt(10)
L_lw1:
    s_waitcnt vmcnt(14)
    s_barrier
    s_nop 0
    ds_read_b128 a[64:67], v18 offset:32768
    v_mfma_f32_16x16x32_bf16 v[88:91], a[36:39], v[44:47], v[88:91]
    ds_read_b128 v[56:59], v22 offset:32768
    s_add_u32 m0, s83, 131072
    s_bfe_u32 s81, s3, 0x3000c
    s_lshl_b32 s81, s81, 7
    s_nop 0
    buffer_load_dwordx4 v10, s[4:7], s81 offen lds
    v_mfma_f32_16x16x32_bf16 v[120:123], a[32:35], v[48:51], 0
    ds_read_b128 a[68:71], v19 offset:32768
    v_mfma_f32_16x16x32_bf16 v[120:123], a[36:39], v[52:55], v[120:123]
    ds_read_b128 v[60:63], v23 offset:32768
    s_waitcnt lgkmcnt(6)
    s_nop 0
    v_mfma_f32_16x16x32_bf16 v[92:95], a[40:43], v[40:43], 0
    ds_read_b128 v[64:67], v22 offset:36864
    v_mfma_f32_16x16x32_bf16 v[92:95], a[44:47], v[44:47], v[92:95]
    ds_read_b128 v[68:71], v23 offset:36864
    buffer_load_dwordx4 v11, s[4:7], s81 offen offset:1024 lds
    v_mfma_f32_16x16x32_bf16 v[124:127], a[40:43], v[48:51], 0
    ds_read_b128 a[72:75], v18 offset:33024
    v_mfma_f32_16x16x32_bf16 v[124:127], a[44:47], v[52:55], v[124:127]
    ds_read_b128 a[76:79], v19 offset:33024
    v_mfma_f32_16x16x32_bf16 v[96:99], a[48:51], v[40:43], 0
    ds_read_b128 a[80:83], v18 offset:33280
    v_mfma_f32_16x16x32_bf16 v[96:99], a[52:55], v[44:47], v[96:99]
    ds_read_b128 a[84:87], v19 offset:33280
    buffer_load_dwordx4 v12, s[4:7], s81 offen offset:2048 lds
    v_mfma_f32_16x16x32_bf16 v[128:131], a[48:51], v[48:51], 0
    v_mfma_f32_16x16x32_bf16 v[128:131], a[52:55], v[52:55], v[128:131]
    s_waitcnt lgkmcnt(8)
    s_nop 0
    v_mfma_f32_16x16x32_bf16 v[100:103], a[56:59], v[40:43], 0
    ds_read_b128 a[88:91], v18 offset:33536
    v_mfma_f32_16x16x32_bf16 v[100:103], a[60:63], v[44:47], v[100:103]
    ds_read_b128 a[92:95], v19 offset:33536
    buffer_load_dwordx4 v13, s[4:7], s81 offen offset:3072 lds
    v_mfma_f32_16x16x32_bf16 v[132:135], a[56:59], v[48:51], 0
    s_add_u32 m0, s83, 147456
    s_mul_i32 s80, s81, s82
    v_mfma_f32_16x16x32_bf16 v[132:135], a[60:63], v[52:55], v[132:135]
    v_mfma_f32_16x16x32_bf16 v[72:75], a[64:67], v[56:59], v[72:75]
    ds_read_b128 a[96:99], v18 offset:33792
    s_waitcnt lgkmcnt(6)
    v_mfma_f32_16x16x32_bf16 v[72:75], a[68:71], v[60:63], v[72:75]
    ds_read_b128 a[100:103], v19 offset:33792
    buffer_load_dwordx4 v14, s[8:11], s80 offen lds
    v_mfma_f32_16x16x32_bf16 v[104:107], a[64:67], v[64:67], v[104:107]
    v_mfma_f32_16x16x32_bf16 v[104:107], a[68:71], v[68:71], v[104:107]
    ds_read_b64 v[234:235], v36 offset:32768
    v_mfma_f32_16x16x32_bf16 v[76:79], a[72:75], v[56:59], v[76:79]
    ds_read_b128 a[104:107], v18 offset:34048
    s_waitcnt lgkmcnt(6)
    s_nop 0
    v_mfma_f32_16x16x32_bf16 v[76:79], a[76:79], v[60:63], v[76:79]
    ds_read_b128 a[108:111], v19 offset:34048
    buffer_load_dwordx4 v15, s[8:11], s80 offen offset:1024 lds
    v_mfma_f32_16x16x32_bf16 v[108:111], a[72:75], v[64:67], v[108:111]
    v_mfma_f32_16x16x32_bf16 v[108:111], a[76:79], v[68:71], v[108:111]
    v_mfma_f32_16x16x32_bf16 v[80:83], a[80:83], v[56:59], v[80:83]
    ds_read_b128 a[112:115], v18 offset:34304
    v_mfma_f32_16x16x32_bf16 v[80:83], a[84:87], v[60:63], v[80:83]
    ds_read_b128 a[116:119], v19 offset:34304
    buffer_load_dwordx4 v16, s[8:11], s80 offen offset:2048 lds
    v_mfma_f32_16x16x32_bf16 v[112:115], a[80:83], v[64:67], v[112:115]
    v_mfma_f32_16x16x32_bf16 v[112:115], a[84:87], v[68:71], v[112:115]
    s_waitcnt lgkmcnt(5)
    s_nop 0
    v_mfma_f32_16x16x32_bf16 v[84:87], a[88:91], v[56:59], v[84:87]
    ds_read_b128 a[120:123], v18 offset:34560
    v_mfma_f32_16x16x32_bf16 v[84:87], a[92:95], v[60:63], v[84:87]
    ds_read_b128 a[124:127], v19 offset:34560
    buffer_load_dwordx4 v17, s[8:11], s80 offen offset:3072 lds
    v_mfma_f32_16x16x32_bf16 v[116:119], a[88:91], v[64:67], v[116:119]
    v_mfma_f32_16x16x32_bf16 v[116:119], a[92:95], v[68:71], v[116:119]
    v_mfma_f32_16x16x32_bf16 v[88:91], a[96:99], v[56:59], v[88:91]
    s_bitcmp1_b32 4, s43
    s_cselect_b32 s98, 0x180000, 0
    buffer_load_dword v254, v252, s[96:99], 0 offen
    s_waitcnt vmcnt(10)
    s_barrier
    s_lshl4_add_u32 s79, s71, s68
    s_sub_u32 s79, s79, 12
    s_cmp_lt_u32 s79, 4
    s_cbranch_scc0 L_nosig
    v_mov_b32_e64 v8, 1
    s_mov_b64 exec, 1
    global_atomic_add v34, v8, s[64:65] sc1
    s_mov_b64 exec, -1
L_nosig:
    s_nop 0
    ds_read_b128 a[128:131], v20 offset:0
    v_mfma_f32_16x16x32_bf16 v[88:91], a[100:103], v[60:63], v[88:91]
    ds_read_b128 v[40:43], v24 offset:0
    s_add_u32 m0, s83, 32768
    s_bfe_u32 s81, s3, 0x30010
    s_lshl_b32 s81, s81, 7
    s_nop 0
    buffer_load_dwordx4 v10, s[4:7], s81 offen lds
    v_mfma_f32_16x16x32_bf16 v[120:123], a[96:99], v[64:67], v[120:123]
    ds_read_b128 a[132:135], v21 offset:0
    v_mfma_f32_16x16x32_bf16 v[120:123], a[100:103], v[68:71], v[120:123]
    ds_read_b128 v[44:47], v25 offset:0
    s_waitcnt lgkmcnt(6)
    s_nop 0
    v_mfma_f32_16x16x32_bf16 v[92:95], a[104:107], v[56:59], v[92:95]
    ds_read_b128 v[48:51], v24 offset:4096
    v_mfma_f32_16x16x32_bf16 v[92:95], a[108:111], v[60:63], v[92:95]
    ds_read_b128 v[52:55], v25 offset:4096
    buffer_load_dwordx4 v11, s[4:7], s81 offen offset:1024 lds
    v_mfma_f32_16x16x32_bf16 v[124:127], a[104:107], v[64:67], v[124:127]
    ds_read_b128 a[136:139], v20 offset:256
    v_mfma_f32_16x16x32_bf16 v[124:127], a[108:111], v[68:71], v[124:127]
    ds_read_b128 a[140:143], v21 offset:256
    v_mfma_f32_16x16x32_bf16 v[96:99], a[112:115], v[56:59], v[96:99]
    ds_read_b128 a[144:147], v20 offset:512
    v_mfma_f32_16x16x32_bf16 v[96:99], a[116:119], v[60:63], v[96:99]
    ds_read_b128 a[148:151], v21 offset:512
    buffer_load_dwordx4 v12, s[4:7], s81 offen offset:2048 lds
    v_mfma_f32_16x16x32_bf16 v[128:131], a[112:115], v[64:67], v[128:131]
    v_mfma_f32_16x16x32_bf16 v[128:131], a[116:119], v[68:71], v[128:131]
    s_waitcnt lgkmcnt(8)
    s_nop 0
    v_mfma_f32_16x16x32_bf16 v[100:103], a[120:123], v[56:59], v[100:103]
    ds_read_b128 a[152:155], v20 offset:768
    v_mfma_f32_16x16x32_bf16 v[100:103], a[124:127], v[60:63], v[100:103]
    ds_read_b128 a[156:159], v21 offset:768
    buffer_load_dwordx4 v13, s[4:7], s81 offen offset:3072 lds
    v_mfma_f32_16x16x32_bf16 v[132:135], a[120:123], v[64:67], v[132:135]
    s_add_u32 m0, s83, 49152
    s_mul_i32 s80, s81, s82
    v_mfma_f32_16x16x32_bf16 v[132:135], a[124:127], v[68:71], v[132:135]
    v_mfma_f32_16x16x32_bf16 v[72:75], a[128:131], v[40:43], v[72:75]
    ds_read_b128 a[160:163], v20 offset:1024
    s_waitcnt lgkmcnt(6)
    v_mfma_f32_16x16x32_bf16 v[72:75], a[132:135], v[44:47], v[72:75]
    ds_read_b128 a[164:167], v21 offset:1024
    buffer_load_dwordx4 v14, s[8:11], s80 offen lds
    v_mfma_f32_16x16x32_bf16 v[104:107], a[128:131], v[48:51], v[104:107]
    v_mfma_f32_16x16x32_bf16 v[104:107], a[132:135], v[52:55], v[104:107]
    ds_read_b64 v[236:237], v37 offset:0
    v_mfma_f32_16x16x32_bf16 v[76:79], a[136:139], v[40:43], v[76:79]
    ds_read_b128 a[168:171], v20 offset:1280
    s_waitcnt lgkmcnt(6)
    s_nop 0
    v_mfma_f32_16x16x32_bf16 v[76:79], a[140:143], v[44:47], v[76:79]
    ds_read_b128 a[172:175], v21 offset:1280
    buffer_load_dwordx4 v15, s[8:11], s80 offen offset:1024 lds
    v_mfma_f32_16x16x32_bf16 v[108:111], a[136:139], v[48:51], v[108:111]
    v_mfma_f32_16x16x32_bf16 v[108:111], a[140:143], v[52:55], v[108:111]
    v_mfma_f32_16x16x32_bf16 v[80:83], a[144:147], v[40:43], v[80:83]
    ds_read_b128 a[176:179], v20 offset:1536
    v_mfma_f32_16x16x32_bf16 v[80:83], a[148:151], v[44:47], v[80:83]
    ds_read_b128 a[180:183], v21 offset:1536
    buffer_load_dwordx4 v16, s[8:11], s80 offen offset:2048 lds
    v_mfma_f32_16x16x32_bf16 v[112:115], a[144:147], v[48:51], v[112:115]
    v_mfma_f32_16x16x32_bf16 v[112:115], a[148:151], v[52:55], v[112:115]
    s_waitcnt lgkmcnt(5)
    s_nop 0
    v_mfma_f32_16x16x32_bf16 v[84:87], a[152:155], v[40:43], v[84:87]
    ds_read_b128 a[184:187], v20 offset:1792
    v_mfma_f32_16x16x32_bf16 v[84:87], a[156:159], v[44:47], v[84:87]
    ds_read_b128 a[188:191], v21 offset:1792
    buffer_load_dwordx4 v17, s[8:11], s80 offen offset:3072 lds
    v_mfma_f32_16x16x32_bf16 v[116:119], a[152:155], v[48:51], v[116:119]
    v_mfma_f32_16x16x32_bf16 v[116:119], a[156:159], v[52:55], v[116:119]
    v_mfma_f32_16x16x32_bf16 v[88:91], a[160:163], v[40:43], v[88:91]
    s_bitcmp1_b32 8, s43
    s_cselect_b32 s98, 0x180000, 0
    buffer_load_dword v254, v252, s[96:99], 0 offen
    s_waitcnt vmcnt(10)
    s_barrier
    s_nop 0
    ds_read_b128 a[192:195], v20 offset:32768
    v_mfma_f32_16x16x32_bf16 v[88:91], a[164:167], v[44:47], v[88:91]
    ds_read_b128 v[56:59], v24 offset:32768
    s_add_u32 m0, s83, 65536
    v_mfma_f32_16x16x32_bf16 v[120:123], a[160:163], v[48:51], v[120:123]
    ds_read_b128 a[196:199], v21 offset:32768
    s_bfe_u32 s81, s3, 0x30014
    s_lshl_b32 s81, s81, 7
    buffer_load_dwordx4 v10, s[4:7], s81 offen lds
    v_mfma_f32_16x16x32_bf16 v[120:123], a[164:167], v[52:55], v[120:123]
    ds_read_b128 v[60:63], v25 offset:32768
    s_waitcnt lgkmcnt(6)
    v_mfma_f32_16x16x32_bf16 v[92:95], a[168:171], v[40:43], v[92:95]
    ds_read_b128 v[64:67], v24 offset:36864
    v_mfma_f32_16x16x32_bf16 v[92:95], a[172:175], v[44:47], v[92:95]
    ds_read_b128 v[68:71], v25 offset:36864
    v_mfma_f32_16x16x32_bf16 v[124:127], a[168:171], v[48:51], v[124:127]
    ds_read_b128 a[200:203], v20 offset:33024
    buffer_load_dwordx4 v11, s[4:7], s81 offen offset:1024 lds
    v_mfma_f32_16x16x32_bf16 v[124:127], a[172:175], v[52:55], v[124:127]
    ds_read_b128 a[204:207], v21 offset:33024
    v_mfma_f32_16x16x32_bf16 v[96:99], a[176:179], v[40:43], v[96:99]
    ds_read_b128 a[208:211], v20 offset:33280
    v_mfma_f32_16x16x32_bf16 v[96:99], a[180:183], v[44:47], v[96:99]
    ds_read_b128 a[212:215], v21 offset:33280
    v_mfma_f32_16x16x32_bf16 v[128:131], a[176:179], v[48:51], v[128:131]
    buffer_load_dwordx4 v12, s[4:7], s81 offen offset:2048 lds
    v_mfma_f32_16x16x32_bf16 v[128:131], a[180:183], v[52:55], v[128:131]
    s_waitcnt lgkmcnt(8)
    s_nop 0
    v_mfma_f32_16x16x32_bf16 v[100:103], a[184:187], v[40:43], v[100:103]
    ds_read_b128 a[216:219], v20 offset:33536
    v_mfma_f32_16x16x32_bf16 v[100:103], a[188:191], v[44:47], v[100:103]
    ds_read_b128 a[220:223], v21 offset:33536
    v_mfma_f32_16x16x32_bf16 v[132:135], a[184:187], v[48:51], v[132:135]
    buffer_load_dwordx4 v13, s[4:7], s81 offen offset:3072 lds
    s_add_u32 m0, s83, 81920
    v_mfma_f32_16x16x32_bf16 v[132:135], a[188:191], v[52:55], v[132:135]
    s_mul_i32 s80, s81, s82
    v_mfma_f32_16x16x32_bf16 v[72:75], a[192:195], v[56:59], v[72:75]
    ds_read_b128 a[224:227], v20 offset:33792
    s_waitcnt lgkmcnt(6)
    v_mfma_f32_16x16x32_bf16 v[72:75], a[196:199], v[60:63], v[72:75]
    ds_read_b128 a[228:231], v21 offset:33792
    v_mfma_f32_16x16x32_bf16 v[104:107], a[192:195], v[64:67], v[104:107]
    buffer_load_dwordx4 v14, s[8:11], s80 offen lds
    v_mfma_f32_16x16x32_bf16 v[104:107], a[196:199], v[68:71], v[104:107]
    ds_read_b64 v[238:239], v37 offset:32768
    v_mfma_f32_16x16x32_bf16 v[76:79], a[200:203], v[56:59], v[76:79]
    ds_read_b128 a[232:235], v20 offset:34048
    s_waitcnt lgkmcnt(6)
    s_nop 0
    v_mfma_f32_16x16x32_bf16 v[76:79], a[204:207], v[60:63], v[76:79]
    ds_read_b128 a[236:239], v21 offset:34048
    v_mfma_f32_16x16x32_bf16 v[108:111], a[200:203], v[64:67], v[108:111]
    buffer_load_dwordx4 v15, s[8:11], s80 offen offset:1024 lds
    v_mfma_f32_16x16x32_bf16 v[108:111], a[204:207], v[68:71], v[108:111]
    v_mfma_f32_16x16x32_bf16 v[80:83], a[208:211], v[56:59], v[80:83]
    ds_read_b128 a[240:243], v20 offset:34304
    v_mfma_f32_16x16x32_bf16 v[80:83], a[212:215], v[60:63], v[80:83]
    ds_read_b128 a[244:247], v21 offset:34304
    v_mfma_f32_16x16x32_bf16 v[112:115], a[208:211], v[64:67], v[112:115]
    buffer_load_dwordx4 v16, s[8:11], s80 offen offset:2048 lds
    v_mfma_f32_16x16x32_bf16 v[112:115], a[212:215], v[68:71], v[112:115]
    s_waitcnt lgkmcnt(5)
    s_nop 0
    v_mfma_f32_16x16x32_bf16 v[84:87], a[216:219], v[56:59], v[84:87]
    ds_read_b128 a[248:251], v20 offset:34560
    v_mfma_f32_16x16x32_bf16 v[84:87], a[220:223], v[60:63], v[84:87]
    ds_read_b128 a[252:255], v21 offset:34560
    v_mfma_f32_16x16x32_bf16 v[116:119], a[216:219], v[64:67], v[116:119]
    buffer_load_dwordx4 v17, s[8:11], s80 offen offset:3072 lds
    v_mfma_f32_16x16x32_bf16 v[116:119], a[220:223], v[68:71], v[116:119]
    v_mfma_f32_16x16x32_bf16 v[88:91], a[224:227], v[56:59], v[88:91]
    s_waitcnt vmcnt(9)
    s_barrier
    ds_read_b128 a[0:3], v18 offset:0
    v_mfma_f32_16x16x32_bf16 v[88:91], a[228:231], v[60:63], v[88:91]
    ds_read_b128 v[40:43], v22 offset:0
    s_add_u32 m0, s83, 98304
    v_mfma_f32_16x16x32_bf16 v[120:123], a[224:227], v[64:67], v[120:123]
    ds_read_b128 a[4:7], v19 offset:0
    s_bfe_u32 s81, s3, 0x30018
    s_lshl_b32 s81, s81, 7
    buffer_load_dwordx4 v10, s[4:7], s81 offen lds
    v_mfma_f32_16x16x32_bf16 v[120:123], a[228:231], v[68:71], v[120:123]
    ds_read_b128 v[44:47], v23 offset:0
    s_waitcnt lgkmcnt(6)
    v_mfma_f32_16x16x32_bf16 v[92:95], a[232:235], v[56:59], v[92:95]
    ds_read_b128 v[48:51], v22 offset:4096
    v_mfma_f32_16x16x32_bf16 v[92:95], a[236:239], v[60:63], v[92:95]
    ds_read_b128 v[52:55], v23 offset:4096
    v_mfma_f32_16x16x32_bf16 v[124:127], a[232:235], v[64:67], v[124:127]
    ds_read_b128 a[8:11], v18 offset:256
    buffer_load_dwordx4 v11, s[4:7], s81 offen offset:1024 lds
    v_mfma_f32_16x16x32_bf16 v[124:127], a[236:239], v[68:71], v[124:127]
    ds_read_b128 a[12:15], v19 offset:256
    v_mfma_f32_16x16x32_bf16 v[96:99], a[240:243], v[56:59], v[96:99]
    ds_read_b128 a[16:19], v18 offset:512
    v_mfma_f32_16x16x32_bf16 v[96:99], a[244:247], v[60:63], v[96:99]
    ds_read_b128 a[20:23], v19 offset:512
    v_mfma_f32_16x16x32_bf16 v[128:131], a[240:243], v[64:67], v[128:131]
    buffer_load_dwordx4 v12, s[4:7], s81 offen offset:2048 lds
    v_mfma_f32_16x16x32_bf16 v[128:131], a[244:247], v[68:71], v[128:131]
    s_waitcnt lgkmcnt(8)
    s_nop 0
    v_mfma_f32_16x16x32_bf16 v[100:103], a[248:251], v[56:59], v[100:103]
    ds_read_b128 a[24:27], v18 offset:768
    v_mfma_f32_16x16x32_bf16 v[100:103], a[252:255], v[60:63], v[100:103]
    ds_read_b128 a[28:31], v19 offset:768
    v_mfma_f32_16x16x32_bf16 v[132:135], a[248:251], v[64:67], v[132:135]
    buffer_load_dwordx4 v13, s[4:7], s81 offen offset:3072 lds
    s_add_u32 m0, s83, 114688
    v_mfma_f32_16x16x32_bf16 v[132:135], a[252:255], v[68:71], v[132:135]
    s_mul_i32 s80, s81, s82
    v_mfma_f32_16x16x32_bf16 v[72:75], a[0:3], v[40:43], v[72:75]
    ds_read_b128 a[32:35], v18 offset:1024
    s_waitcnt lgkmcnt(6)
    v_mfma_f32_16x16x32_bf16 v[72:75], a[4:7], v[44:47], v[72:75]
    ds_read_b128 a[36:39], v19 offset:1024
    v_mfma_f32_16x16x32_bf16 v[104:107], a[0:3], v[48:51], v[104:107]
    buffer_load_dwordx4 v14, s[8:11], s80 offen lds
    v_mfma_f32_16x16x32_bf16 v[104:107], a[4:7], v[52:55], v[104:107]
    ds_read_b64 v[240:241], v36 offset:0
    v_mfma_f32_16x16x32_bf16 v[76:79], a[8:11], v[40:43], v[76:79]
    ds_read_b128 a[40:43], v18 offset:1280
    s_waitcnt lgkmcnt(6)
    s_nop 0
    v_mfma_f32_16x16x32_bf16 v[76:79], a[12:15], v[44:47], v[76:79]
    ds_read_b128 a[44:47], v19 offset:1280
    v_mfma_f32_16x16x32_bf16 v[108:111], a[8:11], v[48:51], v[108:111]
    buffer_load_dwordx4 v15, s[8:11], s80 offen offset:1024 lds
    v_mfma_f32_16x16x32_bf16 v[108:111], a[12:15], v[52:55], v[108:111]
    v_mfma_f32_16x16x32_bf16 v[80:83], a[16:19], v[40:43], v[80:83]
    ds_read_b128 a[48:51], v18 offset:1536
    v_mfma_f32_16x16x32_bf16 v[80:83], a[20:23], v[44:47], v[80:83]
    ds_read_b128 a[52:55], v19 offset:1536
    v_mfma_f32_16x16x32_bf16 v[112:115], a[16:19], v[48:51], v[112:115]
    buffer_load_dwordx4 v16, s[8:11], s80 offen offset:2048 lds
    v_mfma_f32_16x16x32_bf16 v[112:115], a[20:23], v[52:55], v[112:115]
    s_waitcnt lgkmcnt(5)
    s_nop 0
    v_mfma_f32_16x16x32_bf16 v[84:87], a[24:27], v[40:43], v[84:87]
    ds_read_b128 a[56:59], v18 offset:1792
    v_mfma_f32_16x16x32_bf16 v[84:87], a[28:31], v[44:47], v[84:87]
    ds_read_b128 a[60:63], v19 offset:1792
    v_mfma_f32_16x16x32_bf16 v[116:119], a[24:27], v[48:51], v[116:119]
    buffer_load_dwordx4 v17, s[8:11], s80 offen offset:3072 lds
    v_mfma_f32_16x16x32_bf16 v[116:119], a[28:31], v[52:55], v[116:119]
    v_mfma_f32_16x16x32_bf16 v[88:91], a[32:35], v[40:43], v[88:91]
    s_waitcnt vmcnt(8)
    s_barrier
    s_cmp_eq_u32 s72, 0
    s_cselect_b64 s[96:97], s[24:25], s[20:21]
    s_cselect_b32 s79, 0, s73
    s_cselect_b32 s80, 5, 4
    s_mov_b32 s98, 0x80000
    v_lshrrev_b32 v9, s80, v0
    v_lshlrev_b32 v8, 7, v0
    v_lshl_or_b32 v8, v9, 28, v8
    s_lshl3_add_u32 s80, s68, s69
    s_lshl1_add_u32 s80, s80, s79
    s_lshl_b32 s80, s80, 11
    s_nop 0
    buffer_load_dword v254, v8, s[96:99], s80 offen
    ds_read_b128 a[64:67], v18 offset:32768
    v_mfma_f32_16x16x32_bf16 v[88:91], a[36:39], v[44:47], v[88:91]
    ds_read_b128 v[56:59], v22 offset:32768
    s_add_u32 m0, s83, 131072
    v_mfma_f32_16x16x32_bf16 v[120:123], a[32:35], v[48:51], v[120:123]
    ds_read_b128 a[68:71], v19 offset:32768
    s_bfe_u32 s81, s3, 0x3001c
    s_lshl_b32 s81, s81, 7
    buffer_load_dwordx4 v10, s[4:7], s81 offen lds
    v_mfma_f32_16x16x32_bf16 v[120:123], a[36:39], v[52:55], v[120:123]
    ds_read_b128 v[60:63], v23 offset:32768
    s_waitcnt lgkmcnt(6)
    v_mfma_f32_16x16x32_bf16 v[92:95], a[40:43], v[40:43], v[92:95]
    ds_read_b128 v[64:67], v22 offset:36864
    v_mfma_f32_16x16x32_bf16 v[92:95], a[44:47], v[44:47], v[92:95]
    ds_read_b128 v[68:71], v23 offset:36864
    v_mfma_f32_16x16x32_bf16 v[124:127], a[40:43], v[48:51], v[124:127]
    ds_read_b128 a[72:75], v18 offset:33024
    buffer_load_dwordx4 v11, s[4:7], s81 offen offset:1024 lds
    v_mfma_f32_16x16x32_bf16 v[124:127], a[44:47], v[52:55], v[124:127]
    ds_read_b128 a[76:79], v19 offset:33024
    v_mfma_f32_16x16x32_bf16 v[96:99], a[48:51], v[40:43], v[96:99]
    ds_read_b128 a[80:83], v18 offset:33280
    v_mfma_f32_16x16x32_bf16 v[96:99], a[52:55], v[44:47], v[96:99]
    ds_read_b128 a[84:87], v19 offset:33280
    v_mfma_f32_16x16x32_bf16 v[128:131], a[48:51], v[48:51], v[128:131]
    buffer_load_dwordx4 v12, s[4:7], s81 offen offset:2048 lds
    v_mfma_f32_16x16x32_bf16 v[128:131], a[52:55], v[52:55], v[128:131]
    s_waitcnt lgkmcnt(8)
    s_nop 0
    v_mfma_f32_16x16x32_bf16 v[100:103], a[56:59], v[40:43], v[100:103]
    ds_read_b128 a[88:91], v18 offset:33536
    v_mfma_f32_16x16x32_bf16 v[100:103], a[60:63], v[44:47], v[100:103]
    ds_read_b128 a[92:95], v19 offset:33536
    v_mfma_f32_16x16x32_bf16 v[132:135], a[56:59], v[48:51], v[132:135]
    buffer_load_dwordx4 v13, s[4:7], s81 offen offset:3072 lds
    s_add_u32 m0, s83, 147456
    v_mfma_f32_16x16x32_bf16 v[132:135], a[60:63], v[52:55], v[132:135]
    s_mul_i32 s80, s81, s82
    v_mfma_f32_16x16x32_bf16 v[72:75], a[64:67], v[56:59], v[72:75]
    ds_read_b128 a[96:99], v18 offset:33792
    s_waitcnt lgkmcnt(6)
    v_mfma_f32_16x16x32_bf16 v[72:75], a[68:71], v[60:63], v[72:75]
    ds_read_b128 a[100:103], v19 offset:33792
    v_mfma_f32_16x16x32_bf16 v[104:107], a[64:67], v[64:67], v[104:107]
    buffer_load_dwordx4 v14, s[8:11], s80 offen lds
    v_mfma_f32_16x16x32_bf16 v[104:107], a[68:71], v[68:71], v[104:107]
    ds_read_b64 v[242:243], v36 offset:32768
    v_mfma_f32_16x16x32_bf16 v[76:79], a[72:75], v[56:59], v[76:79]
    ds_read_b128 a[104:107], v18 offset:34048
    s_waitcnt lgkmcnt(6)
    s_nop 0
    v_mfma_f32_16x16x32_bf16 v[76:79], a[76:79], v[60:63], v[76:79]
    ds_read_b128 a[108:111], v19 offset:34048
    v_mfma_f32_16x16x32_bf16 v[108:111], a[72:75], v[64:67], v[108:111]
    buffer_load_dwordx4 v15, s[8:11], s80 offen offset:1024 lds
    v_mfma_f32_16x16x32_bf16 v[108:111], a[76:79], v[68:71], v[108:111]
    v_mfma_f32_16x16x32_bf16 v[80:83], a[80:83], v[56:59], v[80:83]
    ds_read_b128 a[112:115], v18 offset:34304
    v_mfma_f32_16x16x32_bf16 v[80:83], a[84:87], v[60:63], v[80:83]
    ds_read_b128 a[116:119], v19 offset:34304
    v_mfma_f32_16x16x32_bf16 v[112:115], a[80:83], v[64:67], v[112:115]
    buffer_load_dwordx4 v16, s[8:11], s80 offen offset:2048 lds
    v_mfma_f32_16x16x32_bf16 v[112:115], a[84:87], v[68:71], v[112:115]
    s_waitcnt lgkmcnt(5)
    s_nop 0
    v_mfma_f32_16x16x32_bf16 v[84:87], a[88:91], v[56:59], v[84:87]
    ds_read_b128 a[120:123], v18 offset:34560
    v_mfma_f32_16x16x32_bf16 v[84:87], a[92:95], v[60:63], v[84:87]
    ds_read_b128 a[124:127], v19 offset:34560
    v_mfma_f32_16x16x32_bf16 v[116:119], a[88:91], v[64:67], v[116:119]
    buffer_load_dwordx4 v17, s[8:11], s80 offen offset:3072 lds
    v_mfma_f32_16x16x32_bf16 v[116:119], a[92:95], v[68:71], v[116:119]
    v_mfma_f32_16x16x32_bf16 v[88:91], a[96:99], v[56:59], v[88:91]
    s_waitcnt vmcnt(9)
    s_barrier
    global_load_dword v34, v34, s[64:65] sc1
    s_lshl1_add_u32 m0, s83, 7168
    s_nop 0
    s_nop 0
    global_load_lds_dword v253, s[94:95]
    ds_read_b128 a[128:131], v20 offset:0
    v_mfma_f32_16x16x32_bf16 v[88:91], a[100:103], v[60:63], v[88:91]
    ds_read_b128 v[40:43], v24 offset:0
    s_lshl1_add_u32 m0, s83, 32768
    v_mfma_f32_16x16x32_bf16 v[120:123], a[96:99], v[64:67], v[120:123]
    ds_read_b128 a[132:135], v21 offset:0
    s_xor_b32 s80, s72, s42
    s_xor_b32 s80, s80, 0
    s_lshl_b32 s80, s80, 7
    buffer_load_dwordx4 v248, s[24:27], s80 offen lds
    v_mfma_f32_16x16x32_bf16 v[120:123], a[100:103], v[68:71], v[120:123]
    ds_read_b128 v[44:47], v25 offset:0
    s_waitcnt lgkmcnt(6)
    v_mfma_f32_16x16x32_bf16 v[92:95], a[104:107], v[56:59], v[92:95]
    ds_read_b128 v[48:51], v24 offset:4096
    v_mfma_f32_16x16x32_bf16 v[92:95], a[108:111], v[60:63], v[92:95]
    ds_read_b128 v[52:55], v25 offset:4096
    v_mfma_f32_16x16x32_bf16 v[124:127], a[104:107], v[64:67], v[124:127]
    ds_read_b128 a[136:139], v20 offset:256
    buffer_load_dwordx4 v249, s[24:27], s80 offen offset:1024 lds
    v_mfma_f32_16x16x32_bf16 v[124:127], a[108:111], v[68:71], v[124:127]
    ds_read_b128 a[140:143], v21 offset:256
    v_mfma_f32_16x16x32_bf16 v[96:99], a[112:115], v[56:59], v[96:99]
    ds_read_b128 a[144:147], v20 offset:512
    v_mfma_f32_16x16x32_bf16 v[96:99], a[116:119], v[60:63], v[96:99]
    ds_read_b128 a[148:151], v21 offset:512
    v_mfma_f32_16x16x32_bf16 v[128:131], a[112:115], v[64:67], v[128:131]
    buffer_load_dwordx4 v250, s[24:27], s80 offen offset:2048 lds
    v_mfma_f32_16x16x32_bf16 v[128:131], a[116:119], v[68:71], v[128:131]
    s_waitcnt lgkmcnt(8)
    s_nop 0
    v_mfma_f32_16x16x32_bf16 v[100:103], a[120:123], v[56:59], v[100:103]
    ds_read_b128 a[152:155], v20 offset:768
    v_mfma_f32_16x16x32_bf16 v[100:103], a[124:127], v[60:63], v[100:103]
    ds_read_b128 a[156:159], v21 offset:768
    v_mfma_f32_16x16x32_bf16 v[132:135], a[120:123], v[64:67], v[132:135]
    buffer_load_dwordx4 v251, s[24:27], s80 offen offset:3072 lds
    s_add_u32 m0, m0, 4096
    v_mfma_f32_16x16x32_bf16 v[132:135], a[124:127], v[68:71], v[132:135]
    s_add_u32 s80, s80, 32768
    v_mfma_f32_16x16x32_bf16 v[72:75], a[128:131], v[40:43], v[72:75]
    ds_read_b128 a[160:163], v20 offset:1024
    s_waitcnt lgkmcnt(6)
    s_nop 0
    v_mfma_f32_16x16x32_bf16 v[72:75], a[132:135], v[44:47], v[72:75]
    ds_read_b128 a[164:167], v21 offset:1024
    v_mfma_f32_16x16x32_bf16 v[104:107], a[128:131], v[48:51], v[104:107]
    buffer_load_dwordx4 v248, s[24:27], s80 offen lds
    v_mfma_f32_16x16x32_bf16 v[104:107], a[132:135], v[52:55], v[104:107]
    ds_read_b64 v[244:245], v37 offset:0
    v_mfma_f32_16x16x32_bf16 v[76:79], a[136:139], v[40:43], v[76:79]
    ds_read_b128 a[168:171], v20 offset:1280
    s_waitcnt lgkmcnt(6)
    s_nop 0
    v_mfma_f32_16x16x32_bf16 v[76:79], a[140:143], v[44:47], v[76:79]
    ds_read_b128 a[172:175], v21 offset:1280
    v_mfma_f32_16x16x32_bf16 v[108:111], a[136:139], v[48:51], v[108:111]
    buffer_load_dwordx4 v249, s[24:27], s80 offen offset:1024 lds
    v_mfma_f32_16x16x32_bf16 v[108:111], a[140:143], v[52:55], v[108:111]
    v_mfma_f32_16x16x32_bf16 v[80:83], a[144:147], v[40:43], v[80:83]
    ds_read_b128 a[176:179], v20 offset:1536
    v_mfma_f32_16x16x32_bf16 v[80:83], a[148:151], v[44:47], v[80:83]
    ds_read_b128 a[180:183], v21 offset:1536
    v_mfma_f32_16x16x32_bf16 v[112:115], a[144:147], v[48:51], v[112:115]
    buffer_load_dwordx4 v250, s[24:27], s80 offen offset:2048 lds
    v_mfma_f32_16x16x32_bf16 v[112:115], a[148:151], v[52:55], v[112:115]
    s_waitcnt lgkmcnt(5)
    s_nop 0
    v_mfma_f32_16x16x32_bf16 v[84:87], a[152:155], v[40:43], v[84:87]
    ds_read_b128 a[184:187], v20 offset:1792
    v_mfma_f32_16x16x32_bf16 v[84:87], a[156:159], v[44:47], v[84:87]
    ds_read_b128 a[188:191], v21 offset:1792
    v_mfma_f32_16x16x32_bf16 v[116:119], a[152:155], v[48:51], v[116:119]
    buffer_load_dwordx4 v251, s[24:27], s80 offen offset:3072 lds
    v_mfma_f32_16x16x32_bf16 v[116:119], a[156:159], v[52:55], v[116:119]
    v_mfma_f32_16x16x32_bf16 v[88:91], a[160:163], v[40:43], v[88:91]
    s_waitcnt vmcnt(10)
    s_barrier
    ds_read_b128 a[192:195], v20 offset:32768
    v_mfma_f32_16x16x32_bf16 v[88:91], a[164:167], v[44:47], v[88:91]
    ds_read_b128 v[56:59], v24 offset:32768
    s_lshl1_add_u32 m0, s83, 65536
    v_mfma_f32_16x16x32_bf16 v[120:123], a[160:163], v[48:51], v[120:123]
    ds_read_b128 a[196:199], v21 offset:32768
    s_xor_b32 s80, s72, s42
    s_xor_b32 s80, s80, 4
    s_lshl_b32 s80, s80, 7
    buffer_load_dwordx4 v248, s[24:27], s80 offen lds
    v_mfma_f32_16x16x32_bf16 v[120:123], a[164:167], v[52:55], v[120:123]
    ds_read_b128 v[60:63], v25 offset:32768
    s_waitcnt lgkmcnt(6)
    v_mfma_f32_16x16x32_bf16 v[92:95], a[168:171], v[40:43], v[92:95]
    ds_read_b128 v[64:67], v24 offset:36864
    v_mfma_f32_16x16x32_bf16 v[92:95], a[172:175], v[44:47], v[92:95]
    ds_read_b128 v[68:71], v25 offset:36864
    v_mfma_f32_16x16x32_bf16 v[124:127], a[168:171], v[48:51], v[124:127]
    ds_read_b128 a[200:203], v20 offset:33024
    buffer_load_dwordx4 v249, s[24:27], s80 offen offset:1024 lds
    v_mfma_f32_16x16x32_bf16 v[124:127], a[172:175], v[52:55], v[124:127]
    ds_read_b128 a[204:207], v21 offset:33024
    v_mfma_f32_16x16x32_bf16 v[96:99], a[176:179], v[40:43], v[96:99]
    ds_read_b128 a[208:211], v20 offset:33280
    v_mfma_f32_16x16x32_bf16 v[96:99], a[180:183], v[44:47], v[96:99]
    ds_read_b128 a[212:215], v21 offset:33280
    v_mfma_f32_16x16x32_bf16 v[128:131], a[176:179], v[48:51], v[128:131]
    buffer_load_dwordx4 v250, s[24:27], s80 offen offset:2048 lds
    v_mfma_f32_16x16x32_bf16 v[128:131], a[180:183], v[52:55], v[128:131]
    s_waitcnt lgkmcnt(8)
    s_nop 0
    v_mfma_f32_16x16x32_bf16 v[100:103], a[184:187], v[40:43], v[100:103]
    ds_read_b128 a[216:219], v20 offset:33536
    v_mfma_f32_16x16x32_bf16 v[100:103], a[188:191], v[44:47], v[100:103]
    ds_read_b128 a[220:223], v21 offset:33536
    v_mfma_f32_16x16x32_bf16 v[132:135], a[184:187], v[48:51], v[132:135]
    buffer_load_dwordx4 v251, s[24:27], s80 offen offset:3072 lds
    s_add_u32 m0, m0, 4096
    v_mfma_f32_16x16x32_bf16 v[132:135], a[188:191], v[52:55], v[132:135]
    s_add_u32 s80, s80, 32768
    v_mfma_f32_16x16x32_bf16 v[72:75], a[192:195], v[56:59], v[72:75]
    ds_read_b128 a[224:227], v20 offset:33792
    s_waitcnt lgkmcnt(6)
    s_nop 0
    v_mfma_f32_16x16x32_bf16 v[72:75], a[196:199], v[60:63], v[72:75]
    ds_read_b128 a[228:231], v21 offset:33792
    v_mfma_f32_16x16x32_bf16 v[104:107], a[192:195], v[64:67], v[104:107]
    buffer_load_dwordx4 v248, s[24:27], s80 offen lds
    v_mfma_f32_16x16x32_bf16 v[104:107], a[196:199], v[68:71], v[104:107]
    ds_read_b64 v[246:247], v37 offset:32768
    v_mfma_f32_16x16x32_bf16 v[76:79], a[200:203], v[56:59], v[76:79]
    ds_read_b128 a[232:235], v20 offset:34048
    s_waitcnt lgkmcnt(6)
    s_nop 0
    v_mfma_f32_16x16x32_bf16 v[76:79], a[204:207], v[60:63], v[76:79]
    ds_read_b128 a[236:239], v21 offset:34048
    v_mfma_f32_16x16x32_bf16 v[108:111], a[200:203], v[64:67], v[108:111]
    buffer_load_dwordx4 v249, s[24:27], s80 offen offset:1024 lds
    v_fma_f32 v14, v144, v72, v74
    v_mfma_f32_16x16x32_bf16 v[108:111], a[204:207], v[68:71], v[108:111]
    v_fma_f32 v16, v144, v104, v106
    v_fmac_f32_e64 v14, v195, v104
    v_mfma_f32_16x16x32_bf16 v[80:83], a[208:211], v[56:59], v[80:83]
    ds_read_b128 a[240:243], v20 offset:34304
    v_fmac_f32_e64 v16, v145, v72
    v_mfma_f32_16x16x32_bf16 v[80:83], a[212:215], v[60:63], v[80:83]
    ds_read_b128 a[244:247], v21 offset:34304
    v_fma_f32 v15, v144, v73, v75
    v_mfma_f32_16x16x32_bf16 v[112:115], a[208:211], v[64:67], v[112:115]
    buffer_load_dwordx4 v250, s[24:27], s80 offen offset:2048 lds
    v_fma_f32 v17, v144, v105, v107
    v_mfma_f32_16x16x32_bf16 v[112:115], a[212:215], v[68:71], v[112:115]
    v_fmac_f32 v15, v195, v105
    v_fmac_f32_e64 v17, v145, v73
    s_waitcnt lgkmcnt(5)
    v_mfma_f32_16x16x32_bf16 v[84:87], a[216:219], v[56:59], v[84:87]
    ds_read_b128 a[248:251], v20 offset:34560
    v_fma_f32 v10, v144, v14, v76
    v_mfma_f32_16x16x32_bf16 v[84:87], a[220:223], v[60:63], v[84:87]
    ds_read_b128 a[252:255], v21 offset:34560
    v_fma_f32 v12, v144, v16, v108
    v_mfma_f32_16x16x32_bf16 v[116:119], a[216:219], v[64:67], v[116:119]
    buffer_load_dwordx4 v251, s[24:27], s80 offen offset:3072 lds
    v_fmac_f32_e64 v10, v195, v16
    v_mfma_f32_16x16x32_bf16 v[116:119], a[220:223], v[68:71], v[116:119]
    v_fmac_f32_e64 v12, v145, v14
    v_fma_f32 v11, v144, v15, v77
    v_mfma_f32_16x16x32_bf16 v[88:91], a[224:227], v[56:59], v[88:91]
    v_fma_f32 v13, v144, v17, v109
    v_fmac_f32_e64 v11, v195, v17
    v_mfma_f32_16x16x32_bf16 v[88:91], a[228:231], v[60:63], v[88:91]
    v_fmac_f32_e64 v13, v145, v15
    v_fma_f32 v14, v144, v10, v78
    v_mfma_f32_16x16x32_bf16 v[120:123], a[224:227], v[64:67], v[120:123]
    v_fma_f32 v16, v144, v12, v110
    v_fmac_f32_e64 v14, v195, v12
    v_mfma_f32_16x16x32_bf16 v[120:123], a[228:231], v[68:71], v[120:123]
    v_fmac_f32_e64 v16, v145, v10
    v_fma_f32 v15, v144, v11, v79
    s_waitcnt lgkmcnt(2)
    v_mfma_f32_16x16x32_bf16 v[92:95], a[232:235], v[56:59], v[92:95]
    v_fma_f32 v17, v144, v13, v111
    v_fmac_f32 v15, v195, v13
    v_mfma_f32_16x16x32_bf16 v[92:95], a[236:239], v[60:63], v[92:95]
    v_fmac_f32_e64 v17, v145, v11
    v_fma_f32 v10, v144, v14, v80
    v_mfma_f32_16x16x32_bf16 v[124:127], a[232:235], v[64:67], v[124:127]
    v_fma_f32 v12, v144, v16, v112
    v_fmac_f32_e64 v10, v195, v16
    v_mfma_f32_16x16x32_bf16 v[124:127], a[236:239], v[68:71], v[124:127]
    v_fmac_f32_e64 v12, v145, v14
    v_fma_f32 v11, v144, v15, v81
    v_mfma_f32_16x16x32_bf16 v[96:99], a[240:243], v[56:59], v[96:99]
    v_fma_f32 v13, v144, v17, v113
    v_fmac_f32_e64 v11, v195, v17
    v_mfma_f32_16x16x32_bf16 v[96:99], a[244:247], v[60:63], v[96:99]
    v_fmac_f32_e64 v13, v145, v15
    v_fma_f32 v14, v144, v10, v82
    v_mfma_f32_16x16x32_bf16 v[128:131], a[240:243], v[64:67], v[128:131]
    v_fma_f32 v16, v144, v12, v114
    v_fmac_f32_e64 v14, v195, v12
    v_mfma_f32_16x16x32_bf16 v[128:131], a[244:247], v[68:71], v[128:131]
    v_fmac_f32_e64 v16, v145, v10
    v_fma_f32 v15, v144, v11, v83
    s_waitcnt lgkmcnt(0)
    v_mfma_f32_16x16x32_bf16 v[100:103], a[248:251], v[56:59], v[100:103]
    v_fma_f32 v17, v144, v13, v115
    v_fmac_f32 v15, v195, v13
    v_mfma_f32_16x16x32_bf16 v[100:103], a[252:255], v[60:63], v[100:103]
    v_fmac_f32_e64 v17, v145, v11
    v_mfma_f32_16x16x32_bf16 v[132:135], a[248:251], v[64:67], v[132:135]
    v_mfma_f32_16x16x32_bf16 v[132:135], a[252:255], v[68:71], v[132:135]
    s_waitcnt vmcnt(17)
    v_readfirstlane_b32 s56, v34
    s_mov_b32 s86, 0
    s_cmp_ge_u32 s56, 32
    s_cbranch_scc0 L_lslowS
L_lokS:
    s_nop 0
    v_pk_fma_f32 v[10:11], v[144:145], v[14:15], v[84:85] op_sel:[0,0,0] op_sel_hi:[0,1,1]
    v_pk_fma_f32 v[12:13], v[144:145], v[16:17], v[116:117] op_sel:[0,0,0] op_sel_hi:[0,1,1]
    v_pk_fma_f32 v[10:11], v[144:145], v[16:17], v[10:11] op_sel:[1,0,0] op_sel_hi:[1,1,1] neg_lo:[1,0,0] neg_hi:[1,0,0]
    v_pk_fma_f32 v[12:13], v[144:145], v[14:15], v[12:13] op_sel:[1,0,0] op_sel_hi:[1,1,1]
    v_pk_fma_f32 v[14:15], v[144:145], v[10:11], v[86:87] op_sel:[0,0,0] op_sel_hi:[0,1,1]
    v_pk_fma_f32 v[16:17], v[144:145], v[12:13], v[118:119] op_sel:[0,0,0] op_sel_hi:[0,1,1]
    v_pk_fma_f32 v[14:15], v[144:145], v[12:13], v[14:15] op_sel:[1,0,0] op_sel_hi:[1,1,1] neg_lo:[1,0,0] neg_hi:[1,0,0]
    v_pk_fma_f32 v[16:17], v[144:145], v[10:11], v[16:17] op_sel:[1,0,0] op_sel_hi:[1,1,1]
    v_pk_fma_f32 v[10:11], v[144:145], v[14:15], v[88:89] op_sel:[0,0,0] op_sel_hi:[0,1,1]
    v_pk_fma_f32 v[12:13], v[144:145], v[16:17], v[120:121] op_sel:[0,0,0] op_sel_hi:[0,1,1]
    v_pk_fma_f32 v[10:11], v[144:145], v[16:17], v[10:11] op_sel:[1,0,0] op_sel_hi:[1,1,1] neg_lo:[1,0,0] neg_hi:[1,0,0]
    v_pk_fma_f32 v[12:13], v[144:145], v[14:15], v[12:13] op_sel:[1,0,0] op_sel_hi:[1,1,1]
    v_pk_fma_f32 v[14:15], v[144:145], v[10:11], v[90:91] op_sel:[0,0,0] op_sel_hi:[0,1,1]
    v_pk_fma_f32 v[16:17], v[144:145], v[12:13], v[122:123] op_sel:[0,0,0] op_sel_hi:[0,1,1]
    v_pk_fma_f32 v[14:15], v[144:145], v[12:13], v[14:15] op_sel:[1,0,0] op_sel_hi:[1,1,1] neg_lo:[1,0,0] neg_hi:[1,0,0]
    v_pk_fma_f32 v[16:17], v[144:145], v[10:11], v[16:17] op_sel:[1,0,0] op_sel_hi:[1,1,1]
    v_pk_fma_f32 v[10:11], v[144:145], v[14:15], v[92:93] op_sel:[0,0,0] op_sel_hi:[0,1,1]
    v_pk_fma_f32 v[12:13], v[144:145], v[16:17], v[124:125] op_sel:[0,0,0] op_sel_hi:[0,1,1]
    v_pk_fma_f32 v[10:11], v[144:145], v[16:17], v[10:11] op_sel:[1,0,0] op_sel_hi:[1,1,1] neg_lo:[1,0,0] neg_hi:[1,0,0]
    v_pk_fma_f32 v[12:13], v[144:145], v[14:15], v[12:13] op_sel:[1,0,0] op_sel_hi:[1,1,1]
    v_pk_fma_f32 v[14:15], v[144:145], v[10:11], v[94:95] op_sel:[0,0,0] op_sel_hi:[0,1,1]
    v_pk_fma_f32 v[16:17], v[144:145], v[12:13], v[126:127] op_sel:[0,0,0] op_sel_hi:[0,1,1]
    v_pk_fma_f32 v[14:15], v[144:145], v[12:13], v[14:15] op_sel:[1,0,0] op_sel_hi:[1,1,1] neg_lo:[1,0,0] neg_hi:[1,0,0]
    v_pk_fma_f32 v[16:17], v[144:145], v[10:11], v[16:17] op_sel:[1,0,0] op_sel_hi:[1,1,1]
    v_pk_fma_f32 v[10:11], v[144:145], v[14:15], v[96:97] op_sel:[0,0,0] op_sel_hi:[0,1,1]
    v_pk_fma_f32 v[12:13], v[144:145], v[16:17], v[128:129] op_sel:[0,0,0] op_sel_hi:[0,1,1]
    v_pk_fma_f32 v[10:11], v[144:145], v[16:17], v[10:11] op_sel:[1,0,0] op_sel_hi:[1,1,1] neg_lo:[1,0,0] neg_hi:[1,0,0]
    v_pk_fma_f32 v[12:13], v[144:145], v[14:15], v[12:13] op_sel:[1,0,0] op_sel_hi:[1,1,1]
    v_pk_fma_f32 v[14:15], v[144:145], v[10:11], v[98:99] op_sel:[0,0,0] op_sel_hi:[0,1,1]
    v_pk_fma_f32 v[16:17], v[144:145], v[12:13], v[130:131] op_sel:[0,0,0] op_sel_hi:[0,1,1]
    v_pk_fma_f32 v[14:15], v[144:145], v[12:13], v[14:15] op_sel:[1,0,0] op_sel_hi:[1,1,1] neg_lo:[1,0,0] neg_hi:[1,0,0]
    v_pk_fma_f32 v[16:17], v[144:145], v[10:11], v[16:17] op_sel:[1,0,0] op_sel_hi:[1,1,1]
    v_pk_fma_f32 v[10:11], v[144:145], v[14:15], v[100:101] op_sel:[0,0,0] op_sel_hi:[0,1,1]
    v_pk_fma_f32 v[12:13], v[144:145], v[16:17], v[132:133] op_sel:[0,0,0] op_sel_hi:[0,1,1]
    v_pk_fma_f32 v[10:11], v[144:145], v[16:17], v[10:11] op_sel:[1,0,0] op_sel_hi:[1,1,1] neg_lo:[1,0,0] neg_hi:[1,0,0]
    v_pk_fma_f32 v[12:13], v[144:145], v[14:15], v[12:13] op_sel:[1,0,0] op_sel_hi:[1,1,1]
    v_pk_fma_f32 v[14:15], v[144:145], v[10:11], v[102:103] op_sel:[0,0,0] op_sel_hi:[0,1,1]
    v_pk_fma_f32 v[16:17], v[144:145], v[12:13], v[134:135] op_sel:[0,0,0] op_sel_hi:[0,1,1]
    v_pk_fma_f32 v[14:15], v[144:145], v[12:13], v[14:15] op_sel:[1,0,0] op_sel_hi:[1,1,1] neg_lo:[1,0,0] neg_hi:[1,0,0]
    v_pk_fma_f32 v[16:17], v[144:145], v[10:11], v[16:17] op_sel:[1,0,0] op_sel_hi:[1,1,1]
    v_fma_f32 v15, v200, v14, v15
    v_fma_f32 v17, v200, v16, v17
    v_fma_f32 v15, -v201, v16, v15
    v_fmac_f32 v17, v201, v14
    v_mul_f32 v10, v184, v15
    v_mul_f32_e64 v11, v184, v17
    v_fma_f32 v10, -v185, v17, v10
    v_fmac_f32 v11, v185, v15
    v_mov_b32 v12, v10
    v_mov_b32 v13, v11
    s_nop 0
    v_permlane16_swap_b32 v10, v12
    v_permlane16_swap_b32 v11, v13
    v_pk_add_f32 v[10:11], v[10:11], v[12:13]
    v_mov_b32 v12, v10
    v_mov_b32_e64 v13, v11
    s_nop 0
    v_permlane32_swap_b32 v10, v12
    v_permlane32_swap_b32 v11, v13
    v_pk_add_f32 v[10:11], v[10:11], v[12:13]
    v_min_u32 v10, -2, v10
    v_min_u32 v11, -2, v11
    v_lshlrev_b32_e64 v6, 3, v2
    buffer_store_dwordx2 v[10:11], v35, s[32:35], 0 offen sc1
    s_waitcnt vmcnt(17)
    s_barrier
    ds_read_b64 v[56:57], v6 offset:7168
    ds_read_b64 v[58:59], v6 offset:7296
    ds_read_b64 v[60:61], v6 offset:15360
    ds_read_b64 v[62:63], v6 offset:15488
    ds_read_b64 v[64:65], v6 offset:23552
    ds_read_b64 v[66:67], v6 offset:23680
    ds_read_b64 v[68:69], v6 offset:31744
    ds_read_b64 v[70:71], v6 offset:31872
    s_lshl1_add_u32 m0, s83, 98304
    s_mov_b32 s80, 0
    buffer_load_dwordx4 v228, s[20:23], s80 offen lds
    buffer_load_dwordx4 v229, s[20:23], s80 offen offset:1024 lds
    v_mov_b32 v42, v15
    v_mov_b32 v44, v15
    v_mov_b32 v43, v17
    v_mov_b32 v45, v17
    v_permlane16_swap_b32 v42, v44
    s_nop 0
    v_permlane16_swap_b32 v43, v45
    v_mov_b32 v46, v42
    v_mov_b32 v48, v44
    v_mov_b32 v47, v43
    v_mov_b32 v49, v45
    v_permlane32_swap_b32 v42, v46
    v_permlane32_swap_b32 v44, v48
    v_permlane32_swap_b32 v43, v47
    v_permlane32_swap_b32 v45, v49
    v_fma_f32 v44, v202, v42, v44
    v_fma_f32 v45, v202, v43, v45
    v_fma_f32 v44, -v203, v43, v44
    v_fmac_f32_e64 v45, v203, v42
    v_fma_f32 v46, v202, v44, v46
    v_fma_f32 v47, v202, v45, v47
    buffer_load_dwordx4 v230, s[20:23], s80 offen offset:2048 lds
    buffer_load_dwordx4 v231, s[20:23], s80 offen offset:3072 lds
    v_fma_f32 v46, -v203, v45, v46
    v_fmac_f32_e64 v47, v203, v44
    v_cndmask_b32 v42, 0, v42, s[88:89]
    v_cndmask_b32 v44, v44, v46, s[88:89]
    v_cndmask_b32 v42, v42, v44, s[90:91]
    v_cndmask_b32 v43, 0, v43, s[88:89]
    v_cndmask_b32 v45, v45, v47, s[88:89]
    v_cndmask_b32 v43, v43, v45, s[90:91]
    v_fma_f32 v14, v200, v42, v14
    v_fma_f32 v16, v200, v43, v16
    v_fma_f32 v14, -v201, v43, v14
    v_fmac_f32 v16, v201, v42
    v_mul_f32 v30, v196, v42
    v_mul_f32_e64 v32, v196, v43
    v_fma_f32 v30, -v197, v43, v30
    v_fmac_f32 v32, v197, v42
    v_mul_f32 v31, v196, v14
    v_mul_f32_e64 v33, v196, v16
    v_fma_f32 v31, -v197, v16, v31
    v_fmac_f32_e64 v33, v197, v14
    s_add_u32 m0, m0, 4096
    s_mov_b32 s80, 32768
    buffer_load_dwordx4 v228, s[20:23], s80 offen lds
    buffer_load_dwordx4 v229, s[20:23], s80 offen offset:1024 lds
    s_waitcnt lgkmcnt(7)
    v_dot2_f32_bf16 v40, v232, v56, 0
    v_dot2_f32_bf16 v40, v233, v57, v40
    s_waitcnt lgkmcnt(6)
    v_dot2_f32_bf16 v40, v234, v58, v40
    v_dot2_f32_bf16 v40, v235, v59, v40
    s_waitcnt lgkmcnt(5)
    v_dot2_f32_bf16 v40, v236, v60, v40
    v_dot2_f32_bf16 v40, v237, v61, v40
    s_waitcnt lgkmcnt(4)
    v_dot2_f32_bf16 v40, v238, v62, v40
    v_dot2_f32_bf16 v40, v239, v63, v40
    s_waitcnt lgkmcnt(3)
    v_dot2_f32_bf16 v40, v240, v64, v40
    v_dot2_f32_bf16 v40, v241, v65, v40
    s_waitcnt lgkmcnt(2)
    v_dot2_f32_bf16 v40, v242, v66, v40
    v_dot2_f32_bf16 v40, v243, v67, v40
    s_waitcnt lgkmcnt(1)
    v_dot2_f32_bf16 v40, v244, v68, v40
    v_dot2_f32_bf16 v40, v245, v69, v40
    s_waitcnt lgkmcnt(0)
    v_dot2_f32_bf16 v40, v246, v70, v40
    v_dot2_f32_bf16 v40, v247, v71, v40
    v_pk_mul_f32 v[54:55], v[72:73], v[196:197] op_sel:[0,1] op_sel_hi:[1,1]
    v_pk_mul_f32 v[72:73], v[72:73], v[196:197] op_sel:[0,0] op_sel_hi:[1,0]
    v_pk_fma_f32 v[72:73], v[104:105], v[196:197], v[72:73] op_sel:[0,1,0] op_sel_hi:[1,1,1] neg_lo:[1,0,0] neg_hi:[1,0,0]
    v_pk_fma_f32 v[104:105], v[104:105], v[196:197], v[54:55] op_sel:[0,0,0] op_sel_hi:[1,0,1] neg_lo:[1,0,1] neg_hi:[1,0,1]
    buffer_load_dwordx4 v230, s[20:23], s80 offen offset:2048 lds
    buffer_load_dwordx4 v231, s[20:23], s80 offen offset:3072 lds
    v_add_f32_dpp v40, v40, v40 row_ror:8 row_mask:0xf bank_mask:0xf
    v_pk_mul_f32 v[54:55], v[74:75], v[196:197] op_sel:[0,1] op_sel_hi:[1,1]
    v_pk_mul_f32 v[74:75], v[74:75], v[196:197] op_sel:[0,0] op_sel_hi:[1,0]
    v_pk_fma_f32 v[74:75], v[106:107], v[196:197], v[74:75] op_sel:[0,1,0] op_sel_hi:[1,1,1] neg_lo:[1,0,0] neg_hi:[1,0,0]
    v_pk_fma_f32 v[106:107], v[106:107], v[196:197], v[54:55] op_sel:[0,0,0] op_sel_hi:[1,0,1] neg_lo:[1,0,1] neg_hi:[1,0,1]
    v_add_f32_dpp v40, v40, v40 row_ror:4 row_mask:0xf bank_mask:0xf
    v_pk_mul_f32 v[54:55], v[76:77], v[196:197] op_sel:[0,1] op_sel_hi:[1,1]
    v_pk_mul_f32 v[76:77], v[76:77], v[196:197] op_sel:[0,0] op_sel_hi:[1,0]
    v_pk_fma_f32 v[76:77], v[108:109], v[196:197], v[76:77] op_sel:[0,1,0] op_sel_hi:[1,1,1] neg_lo:[1,0,0] neg_hi:[1,0,0]
    v_pk_fma_f32 v[108:109], v[108:109], v[196:197], v[54:55] op_sel:[0,0,0] op_sel_hi:[1,0,1] neg_lo:[1,0,1] neg_hi:[1,0,1]
    v_add_f32_dpp v40, v40, v40 row_ror:2 row_mask:0xf bank_mask:0xf
    v_pk_mul_f32 v[54:55], v[78:79], v[196:197] op_sel:[0,1] op_sel_hi:[1,1]
    v_pk_mul_f32 v[78:79], v[78:79], v[196:197] op_sel:[0,0] op_sel_hi:[1,0]
    v_pk_fma_f32 v[78:79], v[110:111], v[196:197], v[78:79] op_sel:[0,1,0] op_sel_hi:[1,1,1] neg_lo:[1,0,0] neg_hi:[1,0,0]
    v_pk_fma_f32 v[110:111], v[110:111], v[196:197], v[54:55] op_sel:[0,0,0] op_sel_hi:[1,0,1] neg_lo:[1,0,1] neg_hi:[1,0,1]
    v_add_f32_dpp v40, v40, v40 row_ror:1 row_mask:0xf bank_mask:0xf
    v_pk_mul_f32 v[54:55], v[80:81], v[196:197] op_sel:[0,1] op_sel_hi:[1,1]
    v_pk_mul_f32 v[80:81], v[80:81], v[196:197] op_sel:[0,0] op_sel_hi:[1,0]
    v_pk_fma_f32 v[80:81], v[112:113], v[196:197], v[80:81] op_sel:[0,1,0] op_sel_hi:[1,1,1] neg_lo:[1,0,0] neg_hi:[1,0,0]
    v_pk_fma_f32 v[112:113], v[112:113], v[196:197], v[54:55] op_sel:[0,0,0] op_sel_hi:[1,0,1] neg_lo:[1,0,1] neg_hi:[1,0,1]
    s_lshl1_add_u32 m0, s83, 131072
    s_mov_b32 s80, 262144
    buffer_load_dwordx4 v228, s[20:23], s80 offen lds
    buffer_load_dwordx4 v229, s[20:23], s80 offen offset:1024 lds
    v_mul_f32 v40, 0x3fb8aa3b, v40
    v_pk_mul_f32 v[54:55], v[82:83], v[196:197] op_sel:[0,1] op_sel_hi:[1,1]
    v_pk_mul_f32 v[82:83], v[82:83], v[196:197] op_sel:[0,0] op_sel_hi:[1,0]
    v_pk_fma_f32 v[82:83], v[114:115], v[196:197], v[82:83] op_sel:[0,1,0] op_sel_hi:[1,1,1] neg_lo:[1,0,0] neg_hi:[1,0,0]
    v_pk_fma_f32 v[114:115], v[114:115], v[196:197], v[54:55] op_sel:[0,0,0] op_sel_hi:[1,0,1] neg_lo:[1,0,1] neg_hi:[1,0,1]
    v_exp_f32_e64 v40, v40
    v_pk_mul_f32 v[54:55], v[84:85], v[196:197] op_sel:[0,1] op_sel_hi:[1,1]
    v_pk_mul_f32 v[84:85], v[84:85], v[196:197] op_sel:[0,0] op_sel_hi:[1,0]
    v_pk_fma_f32 v[84:85], v[116:117], v[196:197], v[84:85] op_sel:[0,1,0] op_sel_hi:[1,1,1] neg_lo:[1,0,0] neg_hi:[1,0,0]
    v_pk_fma_f32 v[116:117], v[116:117], v[196:197], v[54:55] op_sel:[0,0,0] op_sel_hi:[1,0,1] neg_lo:[1,0,1] neg_hi:[1,0,1]
    v_add_f32_e64 v40, 1.0, v40
    v_pk_mul_f32 v[54:55], v[86:87], v[196:197] op_sel:[0,1] op_sel_hi:[1,1]
    v_pk_mul_f32 v[86:87], v[86:87], v[196:197] op_sel:[0,0] op_sel_hi:[1,0]
    v_pk_fma_f32 v[86:87], v[118:119], v[196:197], v[86:87] op_sel:[0,1,0] op_sel_hi:[1,1,1] neg_lo:[1,0,0] neg_hi:[1,0,0]
    v_pk_fma_f32 v[118:119], v[118:119], v[196:197], v[54:55] op_sel:[0,0,0] op_sel_hi:[1,0,1] neg_lo:[1,0,1] neg_hi:[1,0,1]
    v_rcp_f32_e64 v40, v40
    v_pk_mul_f32 v[54:55], v[88:89], v[196:197] op_sel:[0,1] op_sel_hi:[1,1]
    v_pk_mul_f32 v[88:89], v[88:89], v[196:197] op_sel:[0,0] op_sel_hi:[1,0]
    v_pk_fma_f32 v[88:89], v[120:121], v[196:197], v[88:89] op_sel:[0,1,0] op_sel_hi:[1,1,1] neg_lo:[1,0,0] neg_hi:[1,0,0]
    v_pk_fma_f32 v[120:121], v[120:121], v[196:197], v[54:55] op_sel:[0,0,0] op_sel_hi:[1,0,1] neg_lo:[1,0,1] neg_hi:[1,0,1]
    buffer_load_dwordx4 v230, s[20:23], s80 offen offset:2048 lds
    buffer_load_dwordx4 v231, s[20:23], s80 offen offset:3072 lds
    v_pk_mul_f32 v[54:55], v[90:91], v[196:197] op_sel:[0,1] op_sel_hi:[1,1]
    v_pk_mul_f32 v[90:91], v[90:91], v[196:197] op_sel:[0,0] op_sel_hi:[1,0]
    v_pk_fma_f32 v[90:91], v[122:123], v[196:197], v[90:91] op_sel:[0,1,0] op_sel_hi:[1,1,1] neg_lo:[1,0,0] neg_hi:[1,0,0]
    v_pk_fma_f32 v[122:123], v[122:123], v[196:197], v[54:55] op_sel:[0,0,0] op_sel_hi:[1,0,1] neg_lo:[1,0,1] neg_hi:[1,0,1]
    v_pk_mul_f32 v[54:55], v[92:93], v[196:197] op_sel:[0,1] op_sel_hi:[1,1]
    v_pk_mul_f32 v[92:93], v[92:93], v[196:197] op_sel:[0,0] op_sel_hi:[1,0]
    v_pk_fma_f32 v[92:93], v[124:125], v[196:197], v[92:93] op_sel:[0,1,0] op_sel_hi:[1,1,1] neg_lo:[1,0,0] neg_hi:[1,0,0]
    v_pk_fma_f32 v[124:125], v[124:125], v[196:197], v[54:55] op_sel:[0,0,0] op_sel_hi:[1,0,1] neg_lo:[1,0,1] neg_hi:[1,0,1]
    v_pk_mul_f32 v[54:55], v[94:95], v[196:197] op_sel:[0,1] op_sel_hi:[1,1]
    v_pk_mul_f32 v[94:95], v[94:95], v[196:197] op_sel:[0,0] op_sel_hi:[1,0]
    v_pk_fma_f32 v[94:95], v[126:127], v[196:197], v[94:95] op_sel:[0,1,0] op_sel_hi:[1,1,1] neg_lo:[1,0,0] neg_hi:[1,0,0]
    v_pk_fma_f32 v[126:127], v[126:127], v[196:197], v[54:55] op_sel:[0,0,0] op_sel_hi:[1,0,1] neg_lo:[1,0,1] neg_hi:[1,0,1]
    v_pk_mul_f32 v[54:55], v[96:97], v[196:197] op_sel:[0,1] op_sel_hi:[1,1]
    v_pk_mul_f32 v[96:97], v[96:97], v[196:197] op_sel:[0,0] op_sel_hi:[1,0]
    v_pk_fma_f32 v[96:97], v[128:129], v[196:197], v[96:97] op_sel:[0,1,0] op_sel_hi:[1,1,1] neg_lo:[1,0,0] neg_hi:[1,0,0]
    v_pk_fma_f32 v[128:129], v[128:129], v[196:197], v[54:55] op_sel:[0,0,0] op_sel_hi:[1,0,1] neg_lo:[1,0,1] neg_hi:[1,0,1]
    v_pk_mul_f32 v[54:55], v[98:99], v[196:197] op_sel:[0,1] op_sel_hi:[1,1]
    v_pk_mul_f32 v[98:99], v[98:99], v[196:197] op_sel:[0,0] op_sel_hi:[1,0]
    v_pk_fma_f32 v[98:99], v[130:131], v[196:197], v[98:99] op_sel:[0,1,0] op_sel_hi:[1,1,1] neg_lo:[1,0,0] neg_hi:[1,0,0]
    v_pk_fma_f32 v[130:131], v[130:131], v[196:197], v[54:55] op_sel:[0,0,0] op_sel_hi:[1,0,1] neg_lo:[1,0,1] neg_hi:[1,0,1]
    v_pk_mul_f32 v[54:55], v[100:101], v[196:197] op_sel:[0,1] op_sel_hi:[1,1]
    v_pk_mul_f32 v[100:101], v[100:101], v[196:197] op_sel:[0,0] op_sel_hi:[1,0]
    v_pk_fma_f32 v[100:101], v[132:133], v[196:197], v[100:101] op_sel:[0,1,0] op_sel_hi:[1,1,1] neg_lo:[1,0,0] neg_hi:[1,0,0]
    v_pk_fma_f32 v[132:133], v[132:133], v[196:197], v[54:55] op_sel:[0,0,0] op_sel_hi:[1,0,1] neg_lo:[1,0,1] neg_hi:[1,0,1]
    v_pk_mul_f32 v[54:55], v[102:103], v[196:197] op_sel:[0,1] op_sel_hi:[1,1]
    v_pk_mul_f32 v[102:103], v[102:103], v[196:197] op_sel:[0,0] op_sel_hi:[1,0]
    v_pk_fma_f32 v[102:103], v[134:135], v[196:197], v[102:103] op_sel:[0,1,0] op_sel_hi:[1,1,1] neg_lo:[1,0,0] neg_hi:[1,0,0]
    v_pk_fma_f32 v[134:135], v[134:135], v[196:197], v[54:55] op_sel:[0,0,0] op_sel_hi:[1,0,1] neg_lo:[1,0,1] neg_hi:[1,0,1]
    buffer_load_dwordx2 v[232:233], v220, s[32:35], 0 offen sc1
    buffer_load_dwordx2 v[234:235], v221, s[32:35], 0 offen sc1
    buffer_load_dwordx2 v[236:237], v222, s[32:35], 0 offen sc1
    buffer_load_dwordx2 v[238:239], v223, s[32:35], 0 offen sc1
    s_add_u32 m0, m0, 4096
    s_mov_b32 s80, 294912
    buffer_load_dwordx4 v228, s[20:23], s80 offen lds
    buffer_load_dwordx4 v229, s[20:23], s80 offen offset:1024 lds
    buffer_load_dwordx4 v230, s[20:23], s80 offen offset:2048 lds
    buffer_load_dwordx4 v231, s[20:23], s80 offen offset:3072 lds
    v_lshlrev_b32_e64 v9, 2, v5
    v_lshl_or_b32 v9, v2, 24, v9
    s_lshl_b32 s77, s68, 5
    s_add_u32 s77, s77, s84
    s_lshl4_add_u32 s77, s77, 6815744
    buffer_store_dword v40, v9, s[12:15], s77 offen sc1
    s_add_u32 s77, s87, 98304
    s_add_u32 s78, s87, 196608
    s_add_u32 s74, s87, 294912
    s_mov_b32 s86, 0
    s_waitcnt vmcnt(5)
L_gchkS:
    v_max_u32_e64 v6, v232, v233
    v_max3_u32 v6, v6, v234, v235
    v_max3_u32 v6, v6, v236, v237
    v_max3_u32 v6, v6, v238, v239
    v_cmp_eq_u32 vcc, -1, v6
    s_cbranch_vccnz L_gslowS
L_gokS:
    v_pk_mul_f32 v[18:19], v[232:233], v[176:177] op_sel:[0,0] op_sel_hi:[1,0]
    v_pk_fma_f32 v[18:19], v[232:233], v[176:177], v[18:19] op_sel:[1,1,0] op_sel_hi:[0,1,1] neg_lo:[1,0,0]
    v_pk_fma_f32 v[18:19], v[234:235], v[178:179], v[18:19] op_sel:[0,0,0] op_sel_hi:[1,0,1]
    v_pk_fma_f32 v[18:19], v[234:235], v[178:179], v[18:19] op_sel:[1,1,0] op_sel_hi:[0,1,1] neg_lo:[1,0,0]
    v_pk_fma_f32 v[18:19], v[236:237], v[180:181], v[18:19] op_sel:[0,0,0] op_sel_hi:[1,0,1]
    v_pk_fma_f32 v[18:19], v[236:237], v[180:181], v[18:19] op_sel:[1,1,0] op_sel_hi:[0,1,1] neg_lo:[1,0,0]
    v_pk_fma_f32 v[18:19], v[238:239], v[182:183], v[18:19] op_sel:[0,0,0] op_sel_hi:[1,0,1]
    v_pk_fma_f32 v[18:19], v[238:239], v[182:183], v[18:19] op_sel:[1,1,0] op_sel_hi:[0,1,1] neg_lo:[1,0,0]
    v_mov_b32 v20, v18
    v_mov_b32_e64 v21, v19
    s_nop 0
    v_permlane16_swap_b32 v18, v20
    v_permlane16_swap_b32 v19, v21
    v_pk_add_f32 v[18:19], v[18:19], v[20:21]
    v_mov_b32 v20, v18
    v_mov_b32_e64 v21, v19
    s_nop 0
    v_permlane32_swap_b32 v18, v20
    v_permlane32_swap_b32 v19, v21
    v_pk_add_f32 v[18:19], v[18:19], v[20:21]
    v_fma_f32 v30, v212, v18, v30
    v_fma_f32 v32, v212, v19, v32
    v_fma_f32 v30, -v213, v19, v30
    v_fmac_f32_e64 v32, v213, v18
    v_fma_f32 v31, v214, v18, v31
    v_fma_f32 v33, v214, v19, v33
    v_fma_f32 v31, -v215, v19, v31
    v_fmac_f32_e64 v33, v215, v18
    v_pk_fma_f32 v[72:73], v[144:145], v[30:31], v[72:73] op_sel:[0,0,0] op_sel_hi:[0,1,1]
    v_pk_fma_f32 v[104:105], v[144:145], v[32:33], v[104:105] op_sel:[0,0,0] op_sel_hi:[0,1,1] neg_lo:[1,0,0] neg_hi:[1,0,0]
    v_pk_fma_f32 v[72:73], v[144:145], v[32:33], v[72:73] op_sel:[1,0,0] op_sel_hi:[1,1,1] neg_lo:[1,0,0] neg_hi:[1,0,0]
    v_pk_fma_f32 v[104:105], v[144:145], v[30:31], v[104:105] op_sel:[1,0,0] op_sel_hi:[1,1,1] neg_lo:[1,0,0] neg_hi:[1,0,0]
    v_pk_fma_f32 v[74:75], v[144:145], v[72:73], v[74:75] op_sel:[0,0,0] op_sel_hi:[0,1,1]
    v_pk_fma_f32 v[106:107], v[144:145], v[104:105], v[106:107] op_sel:[0,0,0] op_sel_hi:[0,1,1]
    v_pk_fma_f32 v[74:75], v[144:145], v[104:105], v[74:75] op_sel:[1,0,0] op_sel_hi:[1,1,1]
    v_pk_fma_f32 v[106:107], v[144:145], v[72:73], v[106:107] op_sel:[1,0,0] op_sel_hi:[1,1,1] neg_lo:[1,0,0] neg_hi:[1,0,0]
    v_pk_fma_f32 v[76:77], v[144:145], v[74:75], v[76:77] op_sel:[0,0,0] op_sel_hi:[0,1,1]
    v_pk_fma_f32 v[108:109], v[144:145], v[106:107], v[108:109] op_sel:[0,0,0] op_sel_hi:[0,1,1]
    v_pk_fma_f32 v[76:77], v[144:145], v[106:107], v[76:77] op_sel:[1,0,0] op_sel_hi:[1,1,1]
    v_pk_fma_f32 v[108:109], v[144:145], v[74:75], v[108:109] op_sel:[1,0,0] op_sel_hi:[1,1,1] neg_lo:[1,0,0] neg_hi:[1,0,0]
    v_pk_fma_f32 v[78:79], v[144:145], v[76:77], v[78:79] op_sel:[0,0,0] op_sel_hi:[0,1,1]
    v_pk_fma_f32 v[110:111], v[144:145], v[108:109], v[110:111] op_sel:[0,0,0] op_sel_hi:[0,1,1]
    v_pk_fma_f32 v[78:79], v[144:145], v[108:109], v[78:79] op_sel:[1,0,0] op_sel_hi:[1,1,1]
    v_pk_fma_f32 v[110:111], v[144:145], v[76:77], v[110:111] op_sel:[1,0,0] op_sel_hi:[1,1,1] neg_lo:[1,0,0] neg_hi:[1,0,0]
    v_pk_fma_f32 v[80:81], v[144:145], v[78:79], v[80:81] op_sel:[0,0,0] op_sel_hi:[0,1,1]
    v_pk_fma_f32 v[112:113], v[144:145], v[110:111], v[112:113] op_sel:[0,0,0] op_sel_hi:[0,1,1]
    v_pk_fma_f32 v[80:81], v[144:145], v[110:111], v[80:81] op_sel:[1,0,0] op_sel_hi:[1,1,1]
    v_pk_fma_f32 v[112:113], v[144:145], v[78:79], v[112:113] op_sel:[1,0,0] op_sel_hi:[1,1,1] neg_lo:[1,0,0] neg_hi:[1,0,0]
    v_pk_fma_f32 v[82:83], v[144:145], v[80:81], v[82:83] op_sel:[0,0,0] op_sel_hi:[0,1,1]
    v_pk_fma_f32 v[114:115], v[144:145], v[112:113], v[114:115] op_sel:[0,0,0] op_sel_hi:[0,1,1]
    v_pk_fma_f32 v[82:83], v[144:145], v[112:113], v[82:83] op_sel:[1,0,0] op_sel_hi:[1,1,1]
    v_pk_fma_f32 v[114:115], v[144:145], v[80:81], v[114:115] op_sel:[1,0,0] op_sel_hi:[1,1,1] neg_lo:[1,0,0] neg_hi:[1,0,0]
    v_pk_fma_f32 v[84:85], v[144:145], v[82:83], v[84:85] op_sel:[0,0,0] op_sel_hi:[0,1,1]
    v_pk_fma_f32 v[116:117], v[144:145], v[114:115], v[116:117] op_sel:[0,0,0] op_sel_hi:[0,1,1]
    v_pk_fma_f32 v[84:85], v[144:145], v[114:115], v[84:85] op_sel:[1,0,0] op_sel_hi:[1,1,1]
    v_pk_fma_f32 v[116:117], v[144:145], v[82:83], v[116:117] op_sel:[1,0,0] op_sel_hi:[1,1,1] neg_lo:[1,0,0] neg_hi:[1,0,0]
    v_pk_fma_f32 v[86:87], v[144:145], v[84:85], v[86:87] op_sel:[0,0,0] op_sel_hi:[0,1,1]
    v_pk_fma_f32 v[118:119], v[144:145], v[116:117], v[118:119] op_sel:[0,0,0] op_sel_hi:[0,1,1]
    v_pk_fma_f32 v[86:87], v[144:145], v[116:117], v[86:87] op_sel:[1,0,0] op_sel_hi:[1,1,1]
    v_pk_fma_f32 v[118:119], v[144:145], v[84:85], v[118:119] op_sel:[1,0,0] op_sel_hi:[1,1,1] neg_lo:[1,0,0] neg_hi:[1,0,0]
    v_cvt_pk_bf16_f32 v72, v72, v73
    v_cvt_pk_bf16_f32 v73, v74, v75
    v_cvt_pk_bf16_f32 v104, v104, v105
    v_cvt_pk_bf16_f32 v105, v106, v107
    v_mfma_f32_16x16x16_bf16 v[40:43], v[72:73], v[136:137], 0
    v_cvt_pk_bf16_f32 v76, v76, v77
    v_cvt_pk_bf16_f32 v77, v78, v79
    v_mfma_f32_16x16x16_bf16 v[44:47], v[104:105], v[136:137], 0
    v_cvt_pk_bf16_f32 v108, v108, v109
    v_cvt_pk_bf16_f32 v109, v110, v111
    v_mfma_f32_16x16x16_bf16 v[48:51], v[76:77], v[136:137], 0
    v_cvt_pk_bf16_f32 v80, v80, v81
    v_cvt_pk_bf16_f32 v81, v82, v83
    v_mfma_f32_16x16x16_bf16 v[52:55], v[108:109], v[136:137], 0
    v_cvt_pk_bf16_f32 v112, v112, v113
    v_cvt_pk_bf16_f32 v113, v114, v115
    v_mfma_f32_16x16x16_bf16 v[56:59], v[80:81], v[136:137], 0
    v_cvt_pk_bf16_f32 v84, v84, v85
    v_cvt_pk_bf16_f32 v85, v86, v87
    v_mfma_f32_16x16x16_bf16 v[60:63], v[112:113], v[136:137], 0
    v_cvt_pk_bf16_f32 v116, v116, v117
    v_cvt_pk_bf16_f32 v117, v118, v119
    v_mfma_f32_16x16x16_bf16 v[64:67], v[84:85], v[136:137], 0
    v_cvt_pk_bf16_f32 v40, v40, v41
    v_cvt_pk_bf16_f32 v41, v42, v43
    v_mfma_f32_16x16x16_bf16 v[68:71], v[116:117], v[136:137], 0
    v_cvt_pk_bf16_f32 v42, v44, v45
    v_cvt_pk_bf16_f32 v43, v46, v47
    buffer_store_dwordx4 v[40:43], v3, s[12:15], s87 offen offset:0 sc1
    v_cvt_pk_bf16_f32 v48, v48, v49
    v_cvt_pk_bf16_f32 v49, v50, v51
    v_cvt_pk_bf16_f32 v50, v52, v53
    v_cvt_pk_bf16_f32 v51, v54, v55
    buffer_store_dwordx4 v[48:51], v3, s[12:15], s87 offen offset:1024 sc1
    v_cvt_pk_bf16_f32 v56, v56, v57
    v_cvt_pk_bf16_f32 v57, v58, v59
    v_cvt_pk_bf16_f32 v58, v60, v61
    v_cvt_pk_bf16_f32 v59, v62, v63
    buffer_store_dwordx4 v[56:59], v3, s[12:15], s77 offen offset:0 sc1
    v_cvt_pk_bf16_f32 v64, v64, v65
    v_cvt_pk_bf16_f32 v65, v66, v67
    v_cvt_pk_bf16_f32 v66, v68, v69
    v_cvt_pk_bf16_f32 v67, v70, v71
    buffer_store_dwordx4 v[64:67], v3, s[12:15], s77 offen offset:1024 sc1
    v_pk_fma_f32 v[88:89], v[144:145], v[86:87], v[88:89] op_sel:[0,0,0] op_sel_hi:[0,1,1]
    v_pk_fma_f32 v[120:121], v[144:145], v[118:119], v[120:121] op_sel:[0,0,0] op_sel_hi:[0,1,1]
    v_pk_fma_f32 v[88:89], v[144:145], v[118:119], v[88:89] op_sel:[1,0,0] op_sel_hi:[1,1,1]
    v_pk_fma_f32 v[120:121], v[144:145], v[86:87], v[120:121] op_sel:[1,0,0] op_sel_hi:[1,1,1] neg_lo:[1,0,0] neg_hi:[1,0,0]
    v_pk_fma_f32 v[90:91], v[144:145], v[88:89], v[90:91] op_sel:[0,0,0] op_sel_hi:[0,1,1]
    v_pk_fma_f32 v[122:123], v[144:145], v[120:121], v[122:123] op_sel:[0,0,0] op_sel_hi:[0,1,1]
    v_pk_fma_f32 v[90:91], v[144:145], v[120:121], v[90:91] op_sel:[1,0,0] op_sel_hi:[1,1,1]
    v_pk_fma_f32 v[122:123], v[144:145], v[88:89], v[122:123] op_sel:[1,0,0] op_sel_hi:[1,1,1] neg_lo:[1,0,0] neg_hi:[1,0,0]
    v_pk_fma_f32 v[92:93], v[144:145], v[90:91], v[92:93] op_sel:[0,0,0] op_sel_hi:[0,1,1]
    v_pk_fma_f32 v[124:125], v[144:145], v[122:123], v[124:125] op_sel:[0,0,0] op_sel_hi:[0,1,1]
    v_pk_fma_f32 v[92:93], v[144:145], v[122:123], v[92:93] op_sel:[1,0,0] op_sel_hi:[1,1,1]
    v_pk_fma_f32 v[124:125], v[144:145], v[90:91], v[124:125] op_sel:[1,0,0] op_sel_hi:[1,1,1] neg_lo:[1,0,0] neg_hi:[1,0,0]
    v_pk_fma_f32 v[94:95], v[144:145], v[92:93], v[94:95] op_sel:[0,0,0] op_sel_hi:[0,1,1]
    v_pk_fma_f32 v[126:127], v[144:145], v[124:125], v[126:127] op_sel:[0,0,0] op_sel_hi:[0,1,1]
    v_pk_fma_f32 v[94:95], v[144:145], v[124:125], v[94:95] op_sel:[1,0,0] op_sel_hi:[1,1,1]
    v_pk_fma_f32 v[126:127], v[144:145], v[92:93], v[126:127] op_sel:[1,0,0] op_sel_hi:[1,1,1] neg_lo:[1,0,0] neg_hi:[1,0,0]
    v_pk_fma_f32 v[96:97], v[144:145], v[94:95], v[96:97] op_sel:[0,0,0] op_sel_hi:[0,1,1]
    v_pk_fma_f32 v[128:129], v[144:145], v[126:127], v[128:129] op_sel:[0,0,0] op_sel_hi:[0,1,1]
    v_pk_fma_f32 v[96:97], v[144:145], v[126:127], v[96:97] op_sel:[1,0,0] op_sel_hi:[1,1,1]
    v_pk_fma_f32 v[128:129], v[144:145], v[94:95], v[128:129] op_sel:[1,0,0] op_sel_hi:[1,1,1] neg_lo:[1,0,0] neg_hi:[1,0,0]
    v_pk_fma_f32 v[98:99], v[144:145], v[96:97], v[98:99] op_sel:[0,0,0] op_sel_hi:[0,1,1]
    v_pk_fma_f32 v[130:131], v[144:145], v[128:129], v[130:131] op_sel:[0,0,0] op_sel_hi:[0,1,1]
    v_pk_fma_f32 v[98:99], v[144:145], v[128:129], v[98:99] op_sel:[1,0,0] op_sel_hi:[1,1,1]
    v_pk_fma_f32 v[130:131], v[144:145], v[96:97], v[130:131] op_sel:[1,0,0] op_sel_hi:[1,1,1] neg_lo:[1,0,0] neg_hi:[1,0,0]
    v_pk_fma_f32 v[100:101], v[144:145], v[98:99], v[100:101] op_sel:[0,0,0] op_sel_hi:[0,1,1]
    v_pk_fma_f32 v[132:133], v[144:145], v[130:131], v[132:133] op_sel:[0,0,0] op_sel_hi:[0,1,1]
    v_pk_fma_f32 v[100:101], v[144:145], v[130:131], v[100:101] op_sel:[1,0,0] op_sel_hi:[1,1,1]
    v_pk_fma_f32 v[132:133], v[144:145], v[98:99], v[132:133] op_sel:[1,0,0] op_sel_hi:[1,1,1] neg_lo:[1,0,0] neg_hi:[1,0,0]
    v_pk_fma_f32 v[102:103], v[144:145], v[100:101], v[102:103] op_sel:[0,0,0] op_sel_hi:[0,1,1]
    v_pk_fma_f32 v[134:135], v[144:145], v[132:133], v[134:135] op_sel:[0,0,0] op_sel_hi:[0,1,1]
    v_pk_fma_f32 v[102:103], v[144:145], v[132:133], v[102:103] op_sel:[1,0,0] op_sel_hi:[1,1,1]
    v_pk_fma_f32 v[134:135], v[144:145], v[100:101], v[134:135] op_sel:[1,0,0] op_sel_hi:[1,1,1] neg_lo:[1,0,0] neg_hi:[1,0,0]
    v_cvt_pk_bf16_f32 v88, v88, v89
    v_cvt_pk_bf16_f32 v89, v90, v91
    v_cvt_pk_bf16_f32 v120, v120, v121
    v_cvt_pk_bf16_f32 v121, v122, v123
    v_mfma_f32_16x16x16_bf16 v[176:179], v[88:89], v[136:137], 0
    v_cvt_pk_bf16_f32 v92, v92, v93
    v_cvt_pk_bf16_f32 v93, v94, v95
    v_mfma_f32_16x16x16_bf16 v[180:183], v[120:121], v[136:137], 0
    v_cvt_pk_bf16_f32 v124, v124, v125
    v_cvt_pk_bf16_f32 v125, v126, v127
    v_mfma_f32_16x16x16_bf16 v[184:187], v[92:93], v[136:137], 0
    v_cvt_pk_bf16_f32 v96, v96, v97
    v_cvt_pk_bf16_f32 v97, v98, v99
    v_mfma_f32_16x16x16_bf16 v[188:191], v[124:125], v[136:137], 0
    v_cvt_pk_bf16_f32 v128, v128, v129
    v_cvt_pk_bf16_f32 v129, v130, v131
    v_mfma_f32_16x16x16_bf16 v[192:195], v[96:97], v[136:137], 0
    v_cvt_pk_bf16_f32 v100, v100, v101
    v_cvt_pk_bf16_f32 v101, v102, v103
    v_mfma_f32_16x16x16_bf16 v[196:199], v[128:129], v[136:137], 0
    v_cvt_pk_bf16_f32 v132, v132, v133
    v_cvt_pk_bf16_f32 v133, v134, v135
    v_mfma_f32_16x16x16_bf16 v[200:203], v[100:101], v[136:137], 0
    v_cvt_pk_bf16_f32 v176, v176, v177
    v_cvt_pk_bf16_f32 v177, v178, v179
    v_mfma_f32_16x16x16_bf16 v[204:207], v[132:133], v[136:137], 0
    v_cvt_pk_bf16_f32 v178, v180, v181
    v_cvt_pk_bf16_f32 v179, v182, v183
    buffer_store_dwordx4 v[176:179], v3, s[12:15], s78 offen offset:0 sc1
    v_cvt_pk_bf16_f32 v184, v184, v185
    v_cvt_pk_bf16_f32 v185, v186, v187
    v_cvt_pk_bf16_f32 v186, v188, v189
    v_cvt_pk_bf16_f32 v187, v190, v191
    buffer_store_dwordx4 v[184:187], v3, s[12:15], s78 offen offset:1024 sc1
    v_cvt_pk_bf16_f32 v192, v192, v193
    v_cvt_pk_bf16_f32 v193, v194, v195
    v_cvt_pk_bf16_f32 v194, v196, v197
    v_cvt_pk_bf16_f32 v195, v198, v199
    buffer_store_dwordx4 v[192:195], v3, s[12:15], s74 offen offset:0 sc1
    v_cvt_pk_bf16_f32 v200, v200, v201
    v_cvt_pk_bf16_f32 v201, v202, v203
    v_cvt_pk_bf16_f32 v202, v204, v205
    v_cvt_pk_bf16_f32 v203, v206, v207
    buffer_store_dwordx4 v[200:203], v3, s[12:15], s74 offen offset:1024 sc1
    s_waitcnt vmcnt(9)
    s_barrier
    s_lshl1_add_u32 m0, s83, 4096
    s_lshl_b32 s80, s52, 7
    buffer_load_dwordx4 v138, s[4:7], s80 offen lds
    s_add_u32 s80, s80, 64512
    buffer_load_dwordx4 v138, s[4:7], s80 offen offset:1024 lds
    s_lshl1_add_u32 m0, s83, 6144
    s_lshl_b32 s80, s76, 7
    buffer_load_dword v139, s[28:31], s80 offen lds
    ds_read_b64_tr_b16 a[0:1], v26 offset:0
    ds_read_b64_tr_b16 a[2:3], v26 offset:2048
    ds_read_b64_tr_b16 a[4:5], v27 offset:0
    ds_read_b64_tr_b16 a[6:7], v27 offset:2048
    ds_read_b64_tr_b16 a[8:9], v28 offset:0
    ds_read_b64_tr_b16 a[10:11], v28 offset:2048
    ds_read_b64_tr_b16 a[12:13], v29 offset:0
    ds_read_b64_tr_b16 a[14:15], v29 offset:2048
    ds_read_b64_tr_b16 a[16:17], v26 offset:4096
    ds_read_b64_tr_b16 a[18:19], v26 offset:6144
    ds_read_b64_tr_b16 a[20:21], v27 offset:4096
    ds_read_b64_tr_b16 a[22:23], v27 offset:6144
    ds_read_b64_tr_b16 a[24:25], v28 offset:4096
    ds_read_b64_tr_b16 a[26:27], v28 offset:6144
    ds_read_b64_tr_b16 a[28:29], v29 offset:4096
    ds_read_b64_tr_b16 a[30:31], v29 offset:6144
    ds_read_b64_tr_b16 a[32:33], v26 offset:8192
    ds_read_b64_tr_b16 a[34:35], v26 offset:10240
    ds_read_b64_tr_b16 a[36:37], v27 offset:8192
    ds_read_b64_tr_b16 a[38:39], v27 offset:10240
    ds_read_b64_tr_b16 a[40:41], v28 offset:8192
    ds_read_b64_tr_b16 a[42:43], v28 offset:10240
    ds_read_b64_tr_b16 a[44:45], v29 offset:8192
    ds_read_b64_tr_b16 a[46:47], v29 offset:10240
    ds_read_b64_tr_b16 a[48:49], v26 offset:12288
    ds_read_b64_tr_b16 a[50:51], v26 offset:14336
    ds_read_b64_tr_b16 a[52:53], v27 offset:12288
    ds_read_b64_tr_b16 a[54:55], v27 offset:14336
    ds_read_b64_tr_b16 a[56:57], v28 offset:12288
    ds_read_b64_tr_b16 a[58:59], v28 offset:14336
    ds_read_b64_tr_b16 a[60:61], v29 offset:12288
    ds_read_b64_tr_b16 a[62:63], v29 offset:14336
    ds_read_b64_tr_b16 a[64:65], v26 offset:16384
    ds_read_b64_tr_b16 a[66:67], v26 offset:18432
    ds_read_b64_tr_b16 a[68:69], v27 offset:16384
    ds_read_b64_tr_b16 a[70:71], v27 offset:18432
    ds_read_b64_tr_b16 a[72:73], v28 offset:16384
    ds_read_b64_tr_b16 a[74:75], v28 offset:18432
    ds_read_b64_tr_b16 a[76:77], v29 offset:16384
    ds_read_b64_tr_b16 a[78:79], v29 offset:18432
    ds_read_b64_tr_b16 a[80:81], v26 offset:20480
    ds_read_b64_tr_b16 a[82:83], v26 offset:22528
    ds_read_b64_tr_b16 a[84:85], v27 offset:20480
    ds_read_b64_tr_b16 a[86:87], v27 offset:22528
    ds_read_b64_tr_b16 a[88:89], v28 offset:20480
    ds_read_b64_tr_b16 a[90:91], v28 offset:22528
    ds_read_b64_tr_b16 a[92:93], v29 offset:20480
    ds_read_b64_tr_b16 a[94:95], v29 offset:22528
    ds_read_b64_tr_b16 a[96:97], v26 offset:24576
    ds_read_b64_tr_b16 a[98:99], v26 offset:26624
    ds_read_b64_tr_b16 a[100:101], v27 offset:24576
    ds_read_b64_tr_b16 a[102:103], v27 offset:26624
    ds_read_b64_tr_b16 a[104:105], v28 offset:24576
    ds_read_b64_tr_b16 a[106:107], v28 offset:26624
    ds_read_b64_tr_b16 a[108:109], v29 offset:24576
    ds_read_b64_tr_b16 a[110:111], v29 offset:26624
    ds_read_b64_tr_b16 a[112:113], v26 offset:28672
    ds_read_b64_tr_b16 a[114:115], v26 offset:30720
    ds_read_b64_tr_b16 a[116:117], v27 offset:28672
    ds_read_b64_tr_b16 a[118:119], v27 offset:30720
    ds_read_b64_tr_b16 a[120:121], v28 offset:28672
    ds_read_b64_tr_b16 a[122:123], v28 offset:30720
    ds_read_b64_tr_b16 a[124:125], v29 offset:28672
    ds_read_b64_tr_b16 a[126:127], v29 offset:30720
    s_waitcnt vmcnt(3)
    s_waitcnt lgkmcnt(0)
    s_barrier
    s_nop 0
    s_atomic_add s60, s[50:51], 0
    s_atomic_add s60, s[50:51], 128
    s_atomic_add s60, s[50:51], 256
    s_atomic_add s60, s[50:51], 384
    s_lshl1_add_u32 m0, s83, 98304
    s_xor_b32 s80, s72, s42
    s_xor_b32 s80, s80, 2
    s_lshl_b32 s80, s80, 7
    s_nop 0
    buffer_load_dwordx4 v248, s[24:27], s80 offen lds
    buffer_load_dwordx4 v249, s[24:27], s80 offen offset:1024 lds
    buffer_load_dwordx4 v250, s[24:27], s80 offen offset:2048 lds
    buffer_load_dwordx4 v251, s[24:27], s80 offen offset:3072 lds
    s_add_u32 m0, m0, 4096
    s_add_u32 s80, s80, 32768
    buffer_load_dwordx4 v248, s[24:27], s80 offen lds
    buffer_load_dwordx4 v249, s[24:27], s80 offen offset:1024 lds
    buffer_load_dwordx4 v250, s[24:27], s80 offen offset:2048 lds
    buffer_load_dwordx4 v251, s[24:27], s80 offen offset:3072 lds
    v_bfe_u32 v6, v0, 3, 1
    v_lshlrev_b32 v6, 1, v6
    v_xor_b32 v6, v6, v5
    v_lshl_add_u32 v13, v2, 3, s53
    v_lshl_add_u32 v12, v6, 9, v13
    v_lshl_add_u32 v14, v5, 4, s53
    v_lshl_add_u32 v15, v6, 4, s54
    v_lshlrev_b32_e64 v7, 4, v2
    v_lshl_add_u32 v10, v6, 16, v7
    v_and_b32_e64 v7, 0x30, v7
    v_lshl_or_b32 v7, v6, 6, v7
    v_lshrrev_b32_e64 v6, 2, v2
    v_lshl_or_b32 v7, v6, 10, v7
    v_add_u32 v11, s55, v7
    v_and_b32 v6, 14, v2
    v_xor_b32_e64 v6, v6, v5
    v_lshl_add_u32 v6, v6, 3, s58
    v_lshl_add_u32 v18, v2, 7, v6
    v_xor_b32 v19, 32, v18
    v_xor_b32 v20, 64, v18
    v_xor_b32 v21, 96, v18
    v_add_u32 v22, 0x10000, v18
    v_add_u32 v23, 0x10000, v19
    v_add_u32 v24, 0x10000, v20
    v_add_u32 v25, 0x10000, v21
    s_mov_b32 s56, 0
    s_atomic_add s56, s[48:49], 0 glc
    s_lshl1_add_u32 m0, s83, 131072
    s_xor_b32 s80, s72, s42
    s_xor_b32 s80, s80, 6
    s_lshl_b32 s80, s80, 7
    buffer_load_dwordx4 v248, s[24:27], s80 offen lds
    buffer_load_dwordx4 v249, s[24:27], s80 offen offset:1024 lds
    buffer_load_dwordx4 v250, s[24:27], s80 offen offset:2048 lds
    buffer_load_dwordx4 v251, s[24:27], s80 offen offset:3072 lds
    s_add_u32 m0, m0, 4096
    s_add_u32 s80, s80, 32768
    buffer_load_dwordx4 v248, s[24:27], s80 offen lds
    buffer_load_dwordx4 v249, s[24:27], s80 offen offset:1024 lds
    buffer_load_dwordx4 v250, s[24:27], s80 offen offset:2048 lds
    buffer_load_dwordx4 v251, s[24:27], s80 offen offset:3072 lds
    s_waitcnt lgkmcnt(0)
    s_mov_b32 s86, 0
    s_add_u32 s56, s56, 1
    s_lshr_b32 s57, s56, s59
    s_bitcmp1_b32 s57, 0
    s_cbranch_scc0 L_p0Sslow
    s_add_u32 s78, s46, 0
    s_nop 0
    buffer_load_dwordx4 a[128:131], v3, s[12:15], s78 offen offset:0 sc1
    buffer_load_dwordx4 a[132:135], v3, s[12:15], s78 offen offset:2048 sc1
    buffer_load_dwordx4 a[136:139], v3, s[12:15], s78 offen offset:1024 sc1
    buffer_load_dwordx4 a[140:143], v3, s[12:15], s78 offen offset:3072 sc1
    s_add_u32 s78, s46, 4096
    buffer_load_dwordx4 a[144:147], v3, s[12:15], s78 offen offset:0 sc1
    buffer_load_dwordx4 a[148:151], v3, s[12:15], s78 offen offset:2048 sc1
    buffer_load_dwordx4 a[152:155], v3, s[12:15], s78 offen offset:1024 sc1
    buffer_load_dwordx4 a[156:159], v3, s[12:15], s78 offen offset:3072 sc1
    s_waitcnt vmcnt(24)
    s_nop 0
    ds_read_b64 v[160:161], v12 offset:4096
    ds_read_b64 v[162:163], v12 offset:4224
    ds_read_b64 v[164:165], v12 offset:4352
    ds_read_b64 v[166:167], v12 offset:4480
    ds_read_b64 v[168:169], v13 offset:6144
    s_lshl_b32 s81, s52, 8
    s_add_u32 s74, s81, 4096
    v_add_u32 v16, 32768, v10
    s_waitcnt lgkmcnt(4)
    v_lshlrev_b32_e64 v144, 16, v160
    v_and_b32 v145, 0xffff0000, v160
    v_lshlrev_b32_e64 v146, 16, v161
    v_and_b32 v147, 0xffff0000, v161
    s_waitcnt lgkmcnt(3)
    v_lshlrev_b32 v148, 16, v162
    v_and_b32 v149, 0xffff0000, v162
    v_lshlrev_b32_e64 v150, 16, v163
    v_and_b32 v151, 0xffff0000, v163
    s_waitcnt lgkmcnt(2)
    v_lshlrev_b32 v152, 16, v164
    v_and_b32 v153, 0xffff0000, v164
    v_lshlrev_b32_e64 v154, 16, v165
    v_and_b32 v155, 0xffff0000, v165
    s_waitcnt lgkmcnt(1)
    v_lshlrev_b32 v156, 16, v166
    v_and_b32 v157, 0xffff0000, v166
    v_lshlrev_b32_e64 v158, 16, v167
    v_and_b32 v159, 0xffff0000, v167
    s_waitcnt lgkmcnt(0)
    v_lshlrev_b32 v170, 16, v169
    v_and_b32 v171, 0xffff0000, v169
    v_and_b32 v169, 0xffff0000, v168
    v_lshlrev_b32_e64 v168, 16, v168
    v_pk_mul_f32 v[144:145], v[144:145], v[168:169]
    v_pk_mul_f32 v[146:147], v[146:147], v[170:171]
    v_pk_mul_f32 v[148:149], v[148:149], v[168:169]
    v_pk_mul_f32 v[150:151], v[150:151], v[170:171]
    v_pk_mul_f32 v[152:153], v[152:153], v[168:169]
    v_pk_mul_f32 v[154:155], v[154:155], v[170:171]
    v_pk_mul_f32 v[156:157], v[156:157], v[168:169]
    v_pk_mul_f32 v[158:159], v[158:159], v[170:171]
L_p0Sjoin:
    s_andn2_b32 s56, 15, s57
    s_cbranch_scc0 L_p0Sall
    s_mov_b32 s56, 0
    s_nop 0
    s_atomic_add s56, s[48:49], 0 glc
L_p0Sall:
    ds_read_b64 v[40:41], v18 offset:0
    ds_read_b64 v[42:43], v18 offset:8192
    ds_read_b64 v[44:45], v19 offset:0
    ds_read_b64 v[46:47], v19 offset:8192
    ds_read_b64 v[48:49], v18 offset:2048
    ds_read_b64 v[50:51], v18 offset:10240
    ds_read_b64 v[52:53], v19 offset:2048
    ds_read_b64 v[54:55], v19 offset:10240
    ds_read_b64 v[56:57], v18 offset:4096
    ds_read_b64 v[58:59], v18 offset:12288
    ds_read_b64 v[60:61], v19 offset:4096
    ds_read_b64 v[62:63], v19 offset:12288
    s_add_u32 s78, s46, 8192
    s_waitcnt vmcnt(7) lgkmcnt(10)
    v_mfma_f32_16x16x32_bf16 v[72:75], a[128:131], v[40:43], 0
    ds_read_b64 v[64:65], v18 offset:6144
    s_bitcmp1_b32 s57, 1
    s_cbranch_scc0 L_p1Sslow
L_p1Sok:
    buffer_load_dwordx4 a[160:163], v3, s[12:15], s78 offen offset:0 sc1
    s_waitcnt vmcnt(7) lgkmcnt(9)
    v_mfma_f32_16x16x32_bf16 v[72:75], a[132:135], v[44:47], v[72:75]
    ds_read_b64 v[66:67], v18 offset:14336
    s_waitcnt vmcnt(5)
    v_mfma_f32_16x16x32_bf16 v[88:91], a[136:139], v[40:43], 0
    ds_read_b64 v[68:69], v19 offset:6144
    v_mfma_f32_16x16x32_bf16 v[88:91], a[140:143], v[44:47], v[88:91]
    ds_read_b64 v[70:71], v19 offset:14336
    s_waitcnt lgkmcnt(10)
    v_mfma_f32_16x16x32_bf16 v[76:79], a[128:131], v[48:51], 0
    ds_read_b64 v[40:41], v20 offset:0
    buffer_load_dwordx4 a[164:167], v3, s[12:15], s78 offen offset:2048 sc1
    s_waitcnt lgkmcnt(9)
    s_nop 0
    v_mfma_f32_16x16x32_bf16 v[76:79], a[132:135], v[52:55], v[76:79]
    ds_read_b64 v[42:43], v20 offset:8192
    v_mfma_f32_16x16x32_bf16 v[92:95], a[136:139], v[48:51], 0
    ds_read_b64 v[44:45], v21 offset:0
    v_mfma_f32_16x16x32_bf16 v[92:95], a[140:143], v[52:55], v[92:95]
    ds_read_b64 v[46:47], v21 offset:8192
    s_waitcnt lgkmcnt(10)
    v_mfma_f32_16x16x32_bf16 v[80:83], a[128:131], v[56:59], 0
    ds_read_b64 v[48:49], v20 offset:2048
    buffer_load_dwordx4 a[168:171], v3, s[12:15], s78 offen offset:1024 sc1
    s_waitcnt lgkmcnt(8)
    v_mfma_f32_16x16x32_bf16 v[80:83], a[132:135], v[60:63], v[80:83]
    ds_read_b64 v[50:51], v20 offset:10240
    v_mfma_f32_16x16x32_bf16 v[96:99], a[136:139], v[56:59], 0
    ds_read_b64 v[52:53], v21 offset:2048
    v_mfma_f32_16x16x32_bf16 v[96:99], a[140:143], v[60:63], v[96:99]
    ds_read_b64 v[54:55], v21 offset:10240
    s_waitcnt lgkmcnt(8)
    s_nop 0
    v_mfma_f32_16x16x32_bf16 v[84:87], a[128:131], v[64:67], 0
    ds_read_b64 v[56:57], v20 offset:4096
    buffer_load_dwordx4 a[172:175], v3, s[12:15], s78 offen offset:3072 sc1
    v_mfma_f32_16x16x32_bf16 v[84:87], a[132:135], v[68:71], v[84:87]
    ds_read_b64 v[58:59], v20 offset:12288
    s_add_u32 s78, s46, 12288
    v_mfma_f32_16x16x32_bf16 v[100:103], a[136:139], v[64:67], 0
    ds_read_b64 v[60:61], v21 offset:4096
    v_mfma_f32_16x16x32_bf16 v[100:103], a[140:143], v[68:71], v[100:103]
    ds_read_b64 v[62:63], v21 offset:12288
    s_waitcnt vmcnt(6) lgkmcnt(8)
    s_nop 0
    v_mfma_f32_16x16x32_bf16 v[72:75], a[144:147], v[40:43], v[72:75]
    ds_read_b64 v[64:65], v20 offset:6144
    buffer_load_dwordx4 a[176:179], v3, s[12:15], s78 offen offset:0 sc1
    v_mfma_f32_16x16x32_bf16 v[72:75], a[148:151], v[44:47], v[72:75]
    ds_read_b64 v[66:67], v20 offset:14336
    s_waitcnt vmcnt(5)
    v_mfma_f32_16x16x32_bf16 v[88:91], a[152:155], v[40:43], v[88:91]
    ds_read_b64 v[68:69], v21 offset:6144
    v_mfma_f32_16x16x32_bf16 v[88:91], a[156:159], v[44:47], v[88:91]
    ds_read_b64 v[70:71], v21 offset:14336
    s_waitcnt lgkmcnt(8)
    v_mfma_f32_16x16x32_bf16 v[76:79], a[144:147], v[48:51], v[76:79]
    ds_read_b64 v[40:41], v18 offset:16384
    buffer_load_dwordx4 a[180:183], v3, s[12:15], s78 offen offset:2048 sc1
    v_mfma_f32_16x16x32_bf16 v[76:79], a[148:151], v[52:55], v[76:79]
    ds_read_b64 v[42:43], v18 offset:24576
    v_mfma_f32_16x16x32_bf16 v[92:95], a[152:155], v[48:51], v[92:95]
    ds_read_b64 v[44:45], v19 offset:16384
    v_mfma_f32_16x16x32_bf16 v[92:95], a[156:159], v[52:55], v[92:95]
    ds_read_b64 v[46:47], v19 offset:24576
    s_waitcnt lgkmcnt(8)
    s_nop 0
    v_mfma_f32_16x16x32_bf16 v[80:83], a[144:147], v[56:59], v[80:83]
    ds_read_b64 v[48:49], v18 offset:18432
    buffer_load_dwordx4 a[184:187], v3, s[12:15], s78 offen offset:1024 sc1
    v_mfma_f32_16x16x32_bf16 v[80:83], a[148:151], v[60:63], v[80:83]
    ds_read_b64 v[50:51], v18 offset:26624
    v_mfma_f32_16x16x32_bf16 v[96:99], a[152:155], v[56:59], v[96:99]
    ds_read_b64 v[52:53], v19 offset:18432
    v_mfma_f32_16x16x32_bf16 v[96:99], a[156:159], v[60:63], v[96:99]
    ds_read_b64 v[54:55], v19 offset:26624
    s_waitcnt lgkmcnt(8)
    s_nop 0
    v_mfma_f32_16x16x32_bf16 v[84:87], a[144:147], v[64:67], v[84:87]
    ds_read_b64 v[56:57], v18 offset:20480
    buffer_load_dwordx4 a[188:191], v3, s[12:15], s78 offen offset:3072 sc1
    v_mfma_f32_16x16x32_bf16 v[84:87], a[148:151], v[68:71], v[84:87]
    ds_read_b64 v[58:59], v18 offset:28672
    s_add_u32 s78, s46, 16384
    v_mfma_f32_16x16x32_bf16 v[100:103], a[152:155], v[64:67], v[100:103]
    ds_read_b64 v[60:61], v19 offset:20480
    v_mfma_f32_16x16x32_bf16 v[100:103], a[156:159], v[68:71], v[100:103]
    ds_read_b64 v[62:63], v19 offset:28672
    s_waitcnt vmcnt(6) lgkmcnt(8)
    v_mfma_f32_16x16x32_bf16 v[72:75], a[160:163], v[40:43], v[72:75]
    ds_read_b64 v[64:65], v18 offset:22528
    s_bitcmp1_b32 s57, 2
    s_cbranch_scc0 L_p2Sslow
L_p2Sok:
    buffer_load_dwordx4 a[192:195], v3, s[12:15], s78 offen offset:0 sc1
    v_mfma_f32_16x16x32_bf16 v[72:75], a[164:167], v[44:47], v[72:75]
    ds_read_b64 v[66:67], v18 offset:30720
    s_waitcnt vmcnt(5)
    v_mfma_f32_16x16x32_bf16 v[88:91], a[168:171], v[40:43], v[88:91]
    ds_read_b64 v[68:69], v19 offset:22528
    v_mfma_f32_16x16x32_bf16 v[88:91], a[172:175], v[44:47], v[88:91]
    ds_read_b64 v[70:71], v19 offset:30720
    s_waitcnt lgkmcnt(8)
    s_nop 0
    v_mfma_f32_16x16x32_bf16 v[76:79], a[160:163], v[48:51], v[76:79]
    ds_read_b64 v[40:41], v20 offset:16384
    buffer_load_dwordx4 a[196:199], v3, s[12:15], s78 offen offset:2048 sc1
    v_mfma_f32_16x16x32_bf16 v[76:79], a[164:167], v[52:55], v[76:79]
    ds_read_b64 v[42:43], v20 offset:24576
    v_mfma_f32_16x16x32_bf16 v[92:95], a[168:171], v[48:51], v[92:95]
    ds_read_b64 v[44:45], v21 offset:16384
    v_mfma_f32_16x16x32_bf16 v[92:95], a[172:175], v[52:55], v[92:95]
    ds_read_b64 v[46:47], v21 offset:24576
    s_waitcnt lgkmcnt(8)
    s_nop 0
    v_mfma_f32_16x16x32_bf16 v[80:83], a[160:163], v[56:59], v[80:83]
    ds_read_b64 v[48:49], v20 offset:18432
    buffer_load_dwordx4 a[200:203], v3, s[12:15], s78 offen offset:1024 sc1
    v_mfma_f32_16x16x32_bf16 v[80:83], a[164:167], v[60:63], v[80:83]
    ds_read_b64 v[50:51], v20 offset:26624
    v_mfma_f32_16x16x32_bf16 v[96:99], a[168:171], v[56:59], v[96:99]
    ds_read_b64 v[52:53], v21 offset:18432
    v_mfma_f32_16x16x32_bf16 v[96:99], a[172:175], v[60:63], v[96:99]
    ds_read_b64 v[54:55], v21 offset:26624
    s_waitcnt lgkmcnt(8)
    s_nop 0
    v_mfma_f32_16x16x32_bf16 v[84:87], a[160:163], v[64:67], v[84:87]
    ds_read_b64 v[56:57], v20 offset:20480
    buffer_load_dwordx4 a[204:207], v3, s[12:15], s78 offen offset:3072 sc1
    v_mfma_f32_16x16x32_bf16 v[84:87], a[164:167], v[68:71], v[84:87]
    ds_read_b64 v[58:59], v20 offset:28672
    s_add_u32 s78, s46, 20480
    v_mfma_f32_16x16x32_bf16 v[100:103], a[168:171], v[64:67], v[100:103]
    ds_read_b64 v[60:61], v21 offset:20480
    v_mfma_f32_16x16x32_bf16 v[100:103], a[172:175], v[68:71], v[100:103]
    ds_read_b64 v[62:63], v21 offset:28672
    s_waitcnt vmcnt(6) lgkmcnt(8)
    v_mfma_f32_16x16x32_bf16 v[72:75], a[176:179], v[40:43], v[72:75]
    s_barrier
    ds_read_b64 v[64:65], v20 offset:22528
    buffer_load_dwordx4 a[208:211], v3, s[12:15], s78 offen offset:0 sc1
    v_mfma_f32_16x16x32_bf16 v[72:75], a[180:183], v[44:47], v[72:75]
    ds_read_b64 v[66:67], v20 offset:30720
    s_waitcnt vmcnt(5)
    v_mfma_f32_16x16x32_bf16 v[88:91], a[184:187], v[40:43], v[88:91]
    ds_read_b64 v[68:69], v21 offset:22528
    v_mfma_f32_16x16x32_bf16 v[88:91], a[188:191], v[44:47], v[88:91]
    ds_read_b64 v[70:71], v21 offset:30720
    s_waitcnt lgkmcnt(8)
    v_mfma_f32_16x16x32_bf16 v[76:79], a[176:179], v[48:51], v[76:79]
    ds_read_b64 v[40:41], v22 offset:0
    buffer_load_dwordx4 a[212:215], v3, s[12:15], s78 offen offset:2048 sc1
    v_mfma_f32_16x16x32_bf16 v[76:79], a[180:183], v[52:55], v[76:79]
    ds_read_b64 v[42:43], v22 offset:8192
    v_mfma_f32_16x16x32_bf16 v[92:95], a[184:187], v[48:51], v[92:95]
    ds_read_b64 v[44:45], v23 offset:0
    v_mfma_f32_16x16x32_bf16 v[92:95], a[188:191], v[52:55], v[92:95]
    ds_read_b64 v[46:47], v23 offset:8192
    s_waitcnt lgkmcnt(8)
    s_nop 0
    v_mfma_f32_16x16x32_bf16 v[80:83], a[176:179], v[56:59], v[80:83]
    ds_read_b64 v[48:49], v22 offset:2048
    buffer_load_dwordx4 a[216:219], v3, s[12:15], s78 offen offset:1024 sc1
    v_mfma_f32_16x16x32_bf16 v[80:83], a[180:183], v[60:63], v[80:83]
    ds_read_b64 v[50:51], v22 offset:10240
    v_mfma_f32_16x16x32_bf16 v[96:99], a[184:187], v[56:59], v[96:99]
    ds_read_b64 v[52:53], v23 offset:2048
    v_mfma_f32_16x16x32_bf16 v[96:99], a[188:191], v[60:63], v[96:99]
    ds_read_b64 v[54:55], v23 offset:10240
    s_waitcnt lgkmcnt(8)
    s_nop 0
    v_mfma_f32_16x16x32_bf16 v[84:87], a[176:179], v[64:67], v[84:87]
    ds_read_b64 v[56:57], v22 offset:4096
    buffer_load_dwordx4 a[220:223], v3, s[12:15], s78 offen offset:3072 sc1
    v_mfma_f32_16x16x32_bf16 v[84:87], a[180:183], v[68:71], v[84:87]
    ds_read_b64 v[58:59], v22 offset:12288
    s_add_u32 s78, s46, 24576
    v_mfma_f32_16x16x32_bf16 v[100:103], a[184:187], v[64:67], v[100:103]
    ds_read_b64 v[60:61], v23 offset:4096
    v_mfma_f32_16x16x32_bf16 v[100:103], a[188:191], v[68:71], v[100:103]
    ds_read_b64 v[62:63], v23 offset:12288
    s_waitcnt vmcnt(6) lgkmcnt(8)
    v_mfma_f32_16x16x32_bf16 v[72:75], a[192:195], v[40:43], v[72:75]
    ds_read_b64 v[64:65], v22 offset:6144
    s_bitcmp1_b32 s57, 3
    s_cbranch_scc0 L_p3Sslow
L_p3Sok:
    buffer_load_dwordx4 a[224:227], v3, s[12:15], s78 offen offset:0 sc1
    v_mfma_f32_16x16x32_bf16 v[72:75], a[196:199], v[44:47], v[72:75]
    ds_read_b64 v[66:67], v22 offset:14336
    s_mov_b32 s56, 0
    s_atomic_add s56, s[48:49], 0 glc
    s_waitcnt vmcnt(5)
    v_mfma_f32_16x16x32_bf16 v[88:91], a[200:203], v[40:43], v[88:91]
    ds_read_b64 v[68:69], v23 offset:6144
    v_mfma_f32_16x16x32_bf16 v[88:91], a[204:207], v[44:47], v[88:91]
    ds_read_b64 v[70:71], v23 offset:14336
    s_waitcnt lgkmcnt(8)
    v_mfma_f32_16x16x32_bf16 v[76:79], a[192:195], v[48:51], v[76:79]
    ds_read_b64 v[40:41], v24 offset:0
    buffer_load_dwordx4 a[228:231], v3, s[12:15], s78 offen offset:2048 sc1
    v_mfma_f32_16x16x32_bf16 v[76:79], a[196:199], v[52:55], v[76:79]
    ds_read_b64 v[42:43], v24 offset:8192
    v_mfma_f32_16x16x32_bf16 v[92:95], a[200:203], v[48:51], v[92:95]
    ds_read_b64 v[44:45], v25 offset:0
    v_mfma_f32_16x16x32_bf16 v[92:95], a[204:207], v[52:55], v[92:95]
    ds_read_b64 v[46:47], v25 offset:8192
    s_waitcnt lgkmcnt(8)
    s_nop 0
    v_mfma_f32_16x16x32_bf16 v[80:83], a[192:195], v[56:59], v[80:83]
    ds_read_b64 v[48:49], v24 offset:2048
    buffer_load_dwordx4 a[232:235], v3, s[12:15], s78 offen offset:1024 sc1
    v_mfma_f32_16x16x32_bf16 v[80:83], a[196:199], v[60:63], v[80:83]
    ds_read_b64 v[50:51], v24 offset:10240
    v_mfma_f32_16x16x32_bf16 v[96:99], a[200:203], v[56:59], v[96:99]
    ds_read_b64 v[52:53], v25 offset:2048
    v_mfma_f32_16x16x32_bf16 v[96:99], a[204:207], v[60:63], v[96:99]
    ds_read_b64 v[54:55], v25 offset:10240
    s_waitcnt lgkmcnt(8)
    s_nop 0
    v_mfma_f32_16x16x32_bf16 v[84:87], a[192:195], v[64:67], v[84:87]
    ds_read_b64 v[56:57], v24 offset:4096
    buffer_load_dwordx4 a[236:239], v3, s[12:15], s78 offen offset:3072 sc1
    v_mfma_f32_16x16x32_bf16 v[84:87], a[196:199], v[68:71], v[84:87]
    ds_read_b64 v[58:59], v24 offset:12288
    s_add_u32 s78, s46, 28672
    v_mfma_f32_16x16x32_bf16 v[100:103], a[200:203], v[64:67], v[100:103]
    ds_read_b64 v[60:61], v25 offset:4096
    v_mfma_f32_16x16x32_bf16 v[100:103], a[204:207], v[68:71], v[100:103]
    ds_read_b64 v[62:63], v25 offset:12288
    s_waitcnt vmcnt(6) lgkmcnt(8)
    s_nop 0
    v_mfma_f32_16x16x32_bf16 v[72:75], a[208:211], v[40:43], v[72:75]
    ds_read_b64 v[64:65], v24 offset:6144
    buffer_load_dwordx4 a[240:243], v3, s[12:15], s78 offen offset:0 sc1
    v_mfma_f32_16x16x32_bf16 v[72:75], a[212:215], v[44:47], v[72:75]
    ds_read_b64 v[66:67], v24 offset:14336
    s_waitcnt vmcnt(5)
    v_mfma_f32_16x16x32_bf16 v[88:91], a[216:219], v[40:43], v[88:91]
    ds_read_b64 v[68:69], v25 offset:6144
    v_mfma_f32_16x16x32_bf16 v[88:91], a[220:223], v[44:47], v[88:91]
    ds_read_b64 v[70:71], v25 offset:14336
    s_waitcnt lgkmcnt(8)
    v_mfma_f32_16x16x32_bf16 v[76:79], a[208:211], v[48:51], v[76:79]
    ds_read_b64 v[40:41], v22 offset:16384
    buffer_load_dwordx4 a[244:247], v3, s[12:15], s78 offen offset:2048 sc1
    v_mfma_f32_16x16x32_bf16 v[76:79], a[212:215], v[52:55], v[76:79]
    ds_read_b64 v[42:43], v22 offset:24576
    v_mfma_f32_16x16x32_bf16 v[92:95], a[216:219], v[48:51], v[92:95]
    ds_read_b64 v[44:45], v23 offset:16384
    v_mfma_f32_16x16x32_bf16 v[92:95], a[220:223], v[52:55], v[92:95]
    ds_read_b64 v[46:47], v23 offset:24576
    s_waitcnt lgkmcnt(8)
    s_nop 0
    v_mfma_f32_16x16x32_bf16 v[80:83], a[208:211], v[56:59], v[80:83]
    ds_read_b64 v[48:49], v22 offset:18432
    buffer_load_dwordx4 a[248:251], v3, s[12:15], s78 offen offset:1024 sc1
    v_mfma_f32_16x16x32_bf16 v[80:83], a[212:215], v[60:63], v[80:83]
    ds_read_b64 v[50:51], v22 offset:26624
    v_mfma_f32_16x16x32_bf16 v[96:99], a[216:219], v[56:59], v[96:99]
    ds_read_b64 v[52:53], v23 offset:18432
    v_mfma_f32_16x16x32_bf16 v[96:99], a[220:223], v[60:63], v[96:99]
    ds_read_b64 v[54:55], v23 offset:26624
    s_waitcnt lgkmcnt(8)
    s_nop 0
    v_mfma_f32_16x16x32_bf16 v[84:87], a[208:211], v[64:67], v[84:87]
    ds_read_b64 v[56:57], v22 offset:20480
    buffer_load_dwordx4 a[252:255], v3, s[12:15], s78 offen offset:3072 sc1
    v_mfma_f32_16x16x32_bf16 v[84:87], a[212:215], v[68:71], v[84:87]
    ds_read_b64 v[58:59], v22 offset:28672
    s_add_u32 s78, s46, 32768
    v_mfma_f32_16x16x32_bf16 v[100:103], a[216:219], v[64:67], v[100:103]
    ds_read_b64 v[60:61], v23 offset:20480
    v_mfma_f32_16x16x32_bf16 v[100:103], a[220:223], v[68:71], v[100:103]
    ds_read_b64 v[62:63], v23 offset:28672
    s_waitcnt vmcnt(6) lgkmcnt(8)
    v_mfma_f32_16x16x32_bf16 v[72:75], a[224:227], v[40:43], v[72:75]
    ds_read_b64 v[64:65], v22 offset:22528
    s_waitcnt lgkmcnt(0)
    s_mov_b32 s86, 0
    s_add_u32 s56, s56, 1
    s_and_b32 s56, s56, s61
    s_cmp_eq_u32 s56, s61
    s_cbranch_scc0 L_paSslow
    s_lshl1_add_u32 m0, s83, 6400
    s_nop 0
    buffer_load_dword v139, s[12:15], s47 offen sc1 lds
    s_lshl_b32 m0, s83, 1
    buffer_load_dwordx4 a[128:131], v3, s[12:15], s78 offen offset:0 sc1
    v_mfma_f32_16x16x32_bf16 v[72:75], a[228:231], v[44:47], v[72:75]
    ds_read_b64 v[66:67], v22 offset:30720
    s_waitcnt vmcnt(6)
    v_mfma_f32_16x16x32_bf16 v[88:91], a[232:235], v[40:43], v[88:91]
    ds_read_b64 v[68:69], v23 offset:22528
    v_mfma_f32_16x16x32_bf16 v[88:91], a[236:239], v[44:47], v[88:91]
    ds_read_b64 v[70:71], v23 offset:30720
    v_mfma_f32_16x16x32_bf16 v[76:79], a[224:227], v[48:51], v[76:79]
    ds_read_b64 v[40:41], v24 offset:16384
    buffer_load_dwordx4 a[132:135], v3, s[12:15], s78 offen offset:2048 sc1
    v_mfma_f32_16x16x32_bf16 v[76:79], a[228:231], v[52:55], v[76:79]
    ds_read_b64 v[42:43], v24 offset:24576
    s_add_u32 s78, s46, 36864
    v_mfma_f32_16x16x32_bf16 v[92:95], a[232:235], v[48:51], v[92:95]
    ds_read_b64 v[44:45], v25 offset:16384
    v_mfma_f32_16x16x32_bf16 v[92:95], a[236:239], v[52:55], v[92:95]
    ds_read_b64 v[46:47], v25 offset:24576
    v_mfma_f32_16x16x32_bf16 v[80:83], a[224:227], v[56:59], v[80:83]
    ds_read_b64 v[48:49], v24 offset:18432
    buffer_load_dwordx4 a[136:139], v3, s[12:15], s78 offen offset:0 sc1
    v_mfma_f32_16x16x32_bf16 v[80:83], a[228:231], v[60:63], v[80:83]
    ds_read_b64 v[50:51], v24 offset:26624
    v_mfma_f32_16x16x32_bf16 v[96:99], a[232:235], v[56:59], v[96:99]
    ds_read_b64 v[52:53], v25 offset:18432
    v_mfma_f32_16x16x32_bf16 v[96:99], a[236:239], v[60:63], v[96:99]
    ds_read_b64 v[54:55], v25 offset:26624
    s_waitcnt lgkmcnt(8)
    s_nop 0
    v_mfma_f32_16x16x32_bf16 v[84:87], a[224:227], v[64:67], v[84:87]
    ds_read_b64 v[56:57], v24 offset:20480
    buffer_load_dwordx4 a[140:143], v3, s[12:15], s78 offen offset:2048 sc1
    v_mfma_f32_16x16x32_bf16 v[84:87], a[228:231], v[68:71], v[84:87]
    ds_read_b64 v[58:59], v24 offset:28672
    s_add_u32 s78, s46, 40960
    v_mfma_f32_16x16x32_bf16 v[100:103], a[232:235], v[64:67], v[100:103]
    ds_read_b64 v[60:61], v25 offset:20480
    v_mfma_f32_16x16x32_bf16 v[100:103], a[236:239], v[68:71], v[100:103]
    ds_read_b64 v[62:63], v25 offset:28672
    s_waitcnt vmcnt(7) lgkmcnt(8)
    s_nop 0
    v_mfma_f32_16x16x32_bf16 v[72:75], a[240:243], v[40:43], v[72:75]
    ds_read_b64 v[64:65], v24 offset:22528
    buffer_load_dwordx4 a[144:147], v3, s[12:15], s78 offen offset:0 sc1
    v_mfma_f32_16x16x32_bf16 v[72:75], a[244:247], v[44:47], v[72:75]
    ds_read_b64 v[66:67], v24 offset:30720
    s_waitcnt vmcnt(6)
    v_mfma_f32_16x16x32_bf16 v[88:91], a[248:251], v[40:43], v[88:91]
    ds_read_b64 v[68:69], v25 offset:22528
    v_mfma_f32_16x16x32_bf16 v[88:91], a[252:255], v[44:47], v[88:91]
    ds_read_b64 v[70:71], v25 offset:30720
    s_waitcnt lgkmcnt(8)
    v_mfma_f32_16x16x32_bf16 v[76:79], a[240:243], v[48:51], v[76:79]
    buffer_load_dwordx4 a[148:151], v3, s[12:15], s78 offen offset:2048 sc1
    s_add_u32 s78, s46, 45056
    v_mfma_f32_16x16x32_bf16 v[76:79], a[244:247], v[52:55], v[76:79]
    v_mfma_f32_16x16x32_bf16 v[92:95], a[248:251], v[48:51], v[92:95]
    v_mfma_f32_16x16x32_bf16 v[92:95], a[252:255], v[52:55], v[92:95]
    s_waitcnt lgkmcnt(4)
    s_nop 0
    v_mfma_f32_16x16x32_bf16 v[80:83], a[240:243], v[56:59], v[80:83]
    buffer_load_dwordx4 a[152:155], v3, s[12:15], s78 offen offset:0 sc1
    v_mfma_f32_16x16x32_bf16 v[80:83], a[244:247], v[60:63], v[80:83]
    v_mfma_f32_16x16x32_bf16 v[96:99], a[248:251], v[56:59], v[96:99]
    v_mfma_f32_16x16x32_bf16 v[96:99], a[252:255], v[60:63], v[96:99]
    s_waitcnt lgkmcnt(0)
    s_nop 0
    v_mfma_f32_16x16x32_bf16 v[84:87], a[240:243], v[64:67], v[84:87]
    buffer_load_dwordx4 a[156:159], v3, s[12:15], s78 offen offset:2048 sc1
    s_add_u32 s78, s46, 32768
    v_mfma_f32_16x16x32_bf16 v[84:87], a[244:247], v[68:71], v[84:87]
    v_mfma_f32_16x16x32_bf16 v[100:103], a[248:251], v[64:67], v[100:103]
    v_mfma_f32_16x16x32_bf16 v[100:103], a[252:255], v[68:71], v[100:103]
L_paSjoin:
    s_waitcnt vmcnt(6)
    s_nop 0
    v_mfma_f32_16x16x32_bf16 v[104:107], a[128:131], a[0:3], 0
    buffer_load_dwordx4 a[160:163], v3, s[12:15], s78 offen offset:1024 sc1
    ds_read_b128 v[180:183], v14 offset:6400
    v_mfma_f32_16x16x32_bf16 v[104:107], a[132:135], a[16:19], v[104:107]
    ds_read_b128 v[184:187], v14 offset:6464
    ds_read_b64 v[172:173], v15 offset:6400
    v_mfma_f32_16x16x32_bf16 v[108:111], a[128:131], a[4:7], 0
    ds_read_b64 v[174:175], v15 offset:6464
    v_mfma_f32_16x16x32_bf16 v[108:111], a[132:135], a[20:23], v[108:111]
    v_mfma_f32_16x16x32_bf16 v[112:115], a[128:131], a[8:11], 0
    buffer_load_dwordx4 a[164:167], v3, s[12:15], s78 offen offset:3072 sc1
    s_add_u32 s78, s46, 36864
    v_mfma_f32_16x16x32_bf16 v[112:115], a[132:135], a[24:27], v[112:115]
    v_mfma_f32_16x16x32_bf16 v[116:119], a[128:131], a[12:15], 0
    v_mfma_f32_16x16x32_bf16 v[116:119], a[132:135], a[28:31], v[116:119]
    s_waitcnt vmcnt(6)
    v_mfma_f32_16x16x32_bf16 v[104:107], a[136:139], a[32:35], v[104:107]
    buffer_load_dwordx4 a[168:171], v3, s[12:15], s78 offen offset:1024 sc1
    s_waitcnt lgkmcnt(3)
    v_mul_f32_e64 v72, v72, v180
    v_mfma_f32_16x16x32_bf16 v[104:107], a[140:143], a[48:51], v[104:107]
    v_mul_f32 v73, v73, v181
    v_mul_f32 v74, v74, v182
    v_mfma_f32_16x16x32_bf16 v[108:111], a[136:139], a[36:39], v[108:111]
    v_mul_f32 v75, v75, v183
    v_mul_f32 v76, v76, v180
    v_mfma_f32_16x16x32_bf16 v[108:111], a[140:143], a[52:55], v[108:111]
    v_mul_f32 v77, v77, v181
    v_mul_f32 v78, v78, v182
    v_mfma_f32_16x16x32_bf16 v[112:115], a[136:139], a[40:43], v[112:115]
    buffer_load_dwordx4 a[172:175], v3, s[12:15], s78 offen offset:3072 sc1
    s_add_u32 s78, s46, 40960
    v_mfma_f32_16x16x32_bf16 v[112:115], a[140:143], a[56:59], v[112:115]
    v_mul_f32 v79, v79, v183
    v_mul_f32 v80, v80, v180
    v_mfma_f32_16x16x32_bf16 v[116:119], a[136:139], a[44:47], v[116:119]
    v_mul_f32 v81, v81, v181
    v_mul_f32 v82, v82, v182
    v_mfma_f32_16x16x32_bf16 v[116:119], a[140:143], a[60:63], v[116:119]
    v_mul_f32 v83, v83, v183
    v_mul_f32_e64 v84, v84, v180
    s_waitcnt vmcnt(6)
    v_mfma_f32_16x16x32_bf16 v[104:107], a[144:147], a[64:67], v[104:107]
    buffer_load_dwordx4 a[176:179], v3, s[12:15], s78 offen offset:1024 sc1
    v_mul_f32_e64 v85, v85, v181
    v_mfma_f32_16x16x32_bf16 v[104:107], a[148:151], a[80:83], v[104:107]
    v_mul_f32 v86, v86, v182
    v_mul_f32 v87, v87, v183
    v_mfma_f32_16x16x32_bf16 v[108:111], a[144:147], a[68:71], v[108:111]
    v_sub_f32 v188, 1.0, v180
    v_sub_f32 v189, 1.0, v181
    v_mfma_f32_16x16x32_bf16 v[108:111], a[148:151], a[84:87], v[108:111]
    v_sub_f32 v190, 1.0, v182
    v_sub_f32 v191, 1.0, v183
    v_mfma_f32_16x16x32_bf16 v[112:115], a[144:147], a[72:75], v[112:115]
    buffer_load_dwordx4 a[180:183], v3, s[12:15], s78 offen offset:3072 sc1
    s_add_u32 s78, s46, 45056
    v_mfma_f32_16x16x32_bf16 v[112:115], a[148:151], a[88:91], v[112:115]
    s_waitcnt lgkmcnt(0)
    v_sub_f32 v192, 1.0, v184
    v_mfma_f32_16x16x32_bf16 v[116:119], a[144:147], a[76:79], v[116:119]
    v_sub_f32 v193, 1.0, v185
    v_sub_f32 v194, 1.0, v186
    v_mfma_f32_16x16x32_bf16 v[116:119], a[148:151], a[92:95], v[116:119]
    v_sub_f32 v195, 1.0, v187
    v_mul_f32_e64 v88, v88, v184
    s_waitcnt vmcnt(6)
    v_mfma_f32_16x16x32_bf16 v[104:107], a[152:155], a[96:99], v[104:107]
    buffer_load_dwordx4 a[184:187], v3, s[12:15], s78 offen offset:1024 sc1
    v_mul_f32_e64 v89, v89, v185
    v_mfma_f32_16x16x32_bf16 v[104:107], a[156:159], a[112:115], v[104:107]
    v_mul_f32 v90, v90, v186
    v_mul_f32 v91, v91, v187
    v_mfma_f32_16x16x32_bf16 v[108:111], a[152:155], a[100:103], v[108:111]
    v_mul_f32 v92, v92, v184
    v_mul_f32 v93, v93, v185
    v_mfma_f32_16x16x32_bf16 v[108:111], a[156:159], a[116:119], v[108:111]
    v_mul_f32 v94, v94, v186
    v_mul_f32 v95, v95, v187
    v_mfma_f32_16x16x32_bf16 v[112:115], a[152:155], a[104:107], v[112:115]
    buffer_load_dwordx4 a[188:191], v3, s[12:15], s78 offen offset:3072 sc1
    v_mul_f32_e64 v96, v96, v184
    v_mfma_f32_16x16x32_bf16 v[112:115], a[156:159], a[120:123], v[112:115]
    v_mul_f32 v97, v97, v185
    v_mul_f32 v98, v98, v186
    v_mfma_f32_16x16x32_bf16 v[116:119], a[152:155], a[108:111], v[116:119]
    v_mul_f32 v99, v99, v187
    v_mul_f32 v100, v100, v184
    v_mfma_f32_16x16x32_bf16 v[116:119], a[156:159], a[124:127], v[116:119]
    v_mul_f32 v101, v101, v185
    v_mul_f32_e64 v102, v102, v186
    s_waitcnt vmcnt(6)
    v_mfma_f32_16x16x32_bf16 v[120:123], a[160:163], a[0:3], 0
    v_fmac_f32 v72, v104, v188
    v_fmac_f32 v73, v105, v189
    v_mfma_f32_16x16x32_bf16 v[120:123], a[164:167], a[16:19], v[120:123]
    ds_write_addtid_b32 v72 offset:0
    v_fmac_f32_e64 v74, v106, v190
    v_mfma_f32_16x16x32_bf16 v[124:127], a[160:163], a[4:7], 0
    ds_write_addtid_b32 v73 offset:256
    v_fmac_f32_e64 v75, v107, v191
    v_mfma_f32_16x16x32_bf16 v[124:127], a[164:167], a[20:23], v[124:127]
    ds_write_addtid_b32 v74 offset:512
    v_fmac_f32_e64 v76, v108, v188
    v_mfma_f32_16x16x32_bf16 v[128:131], a[160:163], a[8:11], 0
    ds_write_addtid_b32 v75 offset:768
    v_fmac_f32_e64 v77, v109, v189
    v_mfma_f32_16x16x32_bf16 v[128:131], a[164:167], a[24:27], v[128:131]
    ds_write_addtid_b32 v76 offset:1024
    v_fmac_f32_e64 v78, v110, v190
    v_mfma_f32_16x16x32_bf16 v[132:135], a[160:163], a[12:15], 0
    ds_write_addtid_b32 v77 offset:1280
    v_fmac_f32_e64 v79, v111, v191
    v_mfma_f32_16x16x32_bf16 v[132:135], a[164:167], a[28:31], v[132:135]
    ds_write_addtid_b32 v78 offset:1536
    v_fmac_f32 v80, v112, v188
    s_waitcnt vmcnt(4)
    v_mfma_f32_16x16x32_bf16 v[120:123], a[168:171], a[32:35], v[120:123]
    ds_write_addtid_b32 v79 offset:1792
    v_fmac_f32_e64 v81, v113, v189
    v_mfma_f32_16x16x32_bf16 v[120:123], a[172:175], a[48:51], v[120:123]
    ds_write_addtid_b32 v80 offset:2048
    v_fmac_f32_e64 v82, v114, v190
    v_mfma_f32_16x16x32_bf16 v[124:127], a[168:171], a[36:39], v[124:127]
    ds_write_addtid_b32 v81 offset:2304
    v_fmac_f32_e64 v83, v115, v191
    v_mfma_f32_16x16x32_bf16 v[124:127], a[172:175], a[52:55], v[124:127]
    ds_write_addtid_b32 v82 offset:2560
    v_fmac_f32_e64 v84, v116, v188
    v_mfma_f32_16x16x32_bf16 v[128:131], a[168:171], a[40:43], v[128:131]
    ds_write_addtid_b32 v83 offset:2816
    v_fmac_f32_e64 v85, v117, v189
    v_mfma_f32_16x16x32_bf16 v[128:131], a[172:175], a[56:59], v[128:131]
    ds_write_addtid_b32 v84 offset:3072
    v_fmac_f32_e64 v86, v118, v190
    v_mfma_f32_16x16x32_bf16 v[132:135], a[168:171], a[44:47], v[132:135]
    ds_write_addtid_b32 v85 offset:3328
    v_fmac_f32_e64 v87, v119, v191
    v_mfma_f32_16x16x32_bf16 v[132:135], a[172:175], a[60:63], v[132:135]
    ds_write_addtid_b32 v86 offset:3584
    ds_write_addtid_b32 v87 offset:3840
    s_waitcnt vmcnt(2)
    v_mfma_f32_16x16x32_bf16 v[120:123], a[176:179], a[64:67], v[120:123]
    v_mul_f32 v103, v103, v187
    v_mfma_f32_16x16x32_bf16 v[120:123], a[180:183], a[80:83], v[120:123]
    v_mfma_f32_16x16x32_bf16 v[124:127], a[176:179], a[68:71], v[124:127]
    s_waitcnt lgkmcnt(0)
    s_barrier
    ds_read_b128 v[40:43], v11 offset:0
    ds_read_b128 v[44:47], v11 offset:8192
    ds_read_b128 v[48:51], v11 offset:256
    ds_read_b128 v[52:55], v11 offset:8448
    v_mfma_f32_16x16x32_bf16 v[124:127], a[180:183], a[84:87], v[124:127]
    v_mfma_f32_16x16x32_bf16 v[128:131], a[176:179], a[72:75], v[128:131]
    v_mfma_f32_16x16x32_bf16 v[128:131], a[180:183], a[88:91], v[128:131]
    v_mfma_f32_16x16x32_bf16 v[132:135], a[176:179], a[76:79], v[132:135]
    s_waitcnt lgkmcnt(3)
    v_fma_f32 v144, v172, v144, v40
    v_mfma_f32_16x16x32_bf16 v[132:135], a[180:183], a[92:95], v[132:135]
    v_fma_f32 v145, v172, v145, v41
    v_fma_f32 v146, v172, v146, v42
    s_waitcnt vmcnt(0)
    v_mfma_f32_16x16x32_bf16 v[120:123], a[184:187], a[96:99], v[120:123]
    v_fma_f32 v147, v172, v147, v43
    s_waitcnt lgkmcnt(2)
    v_add_f32 v144, v144, v44
    v_mfma_f32_16x16x32_bf16 v[120:123], a[188:191], a[112:115], v[120:123]
    v_add_f32 v145, v145, v45
    v_add_f32 v146, v146, v46
    v_mfma_f32_16x16x32_bf16 v[124:127], a[184:187], a[100:103], v[124:127]
    v_add_f32_e64 v147, v147, v47
    buffer_store_dwordx4 v[144:147], v10, s[16:19], s81 offen sc1
    v_mfma_f32_16x16x32_bf16 v[124:127], a[188:191], a[116:119], v[124:127]
    s_waitcnt lgkmcnt(0)
    s_nop 0
    v_fma_f32 v148, v173, v148, v48
    v_mfma_f32_16x16x32_bf16 v[128:131], a[184:187], a[104:107], v[128:131]
    v_fma_f32 v149, v173, v149, v49
    v_fma_f32 v150, v173, v150, v50
    v_mfma_f32_16x16x32_bf16 v[128:131], a[188:191], a[120:123], v[128:131]
    v_fma_f32 v151, v173, v151, v51
    v_add_f32_e64 v148, v148, v52
    v_mfma_f32_16x16x32_bf16 v[132:135], a[184:187], a[108:111], v[132:135]
    v_add_f32 v149, v149, v53
    v_add_f32 v150, v150, v54
    v_mfma_f32_16x16x32_bf16 v[132:135], a[188:191], a[124:127], v[132:135]
    v_add_f32_e64 v151, v151, v55
    buffer_store_dwordx4 v[148:151], v16, s[16:19], s81 offen sc1
    v_fmac_f32 v88, v120, v192
    v_fmac_f32 v89, v121, v193
    v_fmac_f32 v90, v122, v194
    v_fmac_f32 v91, v123, v195
    v_pk_fma_f32 v[92:93], v[124:125], v[192:193], v[92:93]
    v_pk_fma_f32 v[94:95], v[126:127], v[194:195], v[94:95]
    v_pk_fma_f32 v[96:97], v[128:129], v[192:193], v[96:97]
    v_pk_fma_f32 v[98:99], v[130:131], v[194:195], v[98:99]
    ds_write_addtid_b32 v88 offset:4096
    ds_write_addtid_b32 v89 offset:4352
    ds_write_addtid_b32 v90 offset:4608
    ds_write_addtid_b32 v91 offset:4864
    ds_write_addtid_b32 v92 offset:5120
    ds_write_addtid_b32 v93 offset:5376
    ds_write_addtid_b32 v94 offset:5632
    ds_write_addtid_b32 v95 offset:5888
    ds_write_addtid_b32 v96 offset:6144
    ds_write_addtid_b32 v97 offset:6400
    ds_write_addtid_b32 v98 offset:6656
    ds_write_addtid_b32 v99 offset:6912
    v_pk_fma_f32 v[100:101], v[132:133], v[192:193], v[100:101]
    v_pk_fma_f32 v[102:103], v[134:135], v[194:195], v[102:103]
    ds_write_addtid_b32 v100 offset:7168
    ds_write_addtid_b32 v101 offset:7424
    ds_write_addtid_b32 v102 offset:7680
    ds_write_addtid_b32 v103 offset:7936
    s_waitcnt lgkmcnt(0)
    s_barrier
    ds_read_b128 v[40:43], v11 offset:4096
    ds_read_b128 v[44:47], v11 offset:12288
    ds_read_b128 v[48:51], v11 offset:4352
    ds_read_b128 v[52:55], v11 offset:12544
    s_waitcnt lgkmcnt(3)
    v_pk_fma_f32 v[152:153], v[174:175], v[152:153], v[40:41] op_sel:[0,0,0] op_sel_hi:[0,1,1]
    v_pk_fma_f32 v[154:155], v[174:175], v[154:155], v[42:43] op_sel:[0,0,0] op_sel_hi:[0,1,1]
    s_waitcnt lgkmcnt(2)
    v_pk_add_f32 v[152:153], v[152:153], v[44:45]
    v_pk_add_f32 v[154:155], v[154:155], v[46:47]
    buffer_store_dwordx4 v[152:155], v10, s[16:19], s74 offen sc1
    s_waitcnt lgkmcnt(1)
    v_pk_fma_f32 v[156:157], v[174:175], v[156:157], v[48:49] op_sel:[1,0,0] op_sel_hi:[1,1,1]
    v_pk_fma_f32 v[158:159], v[174:175], v[158:159], v[50:51] op_sel:[1,0,0] op_sel_hi:[1,1,1]
    s_waitcnt lgkmcnt(0)
    v_pk_add_f32 v[156:157], v[156:157], v[52:53]
    v_pk_add_f32 v[158:159], v[158:159], v[54:55]
    buffer_store_dwordx4 v[156:159], v16, s[16:19], s74 offen sc1
    s_endpgm
L_roleA:
    s_lshl_b32 s60, 256, s69
    s_lshl_b32 s59, s73, 2
    s_lshl_b32 s61, 0xf00, s59
    s_or_b32 s61, s61, 0xff
    v_bfe_u32 v6, v0, 2, 2
    v_mad_u32_u24 v6, v5, 8, v6
    v_lshlrev_b32 v30, 7, v6
    v_and_b32 v6, 3, v0
    v_lshl_add_u32 v30, v6, 3, v30
    v_bfe_u32 v6, v0, 3, 2
    v_lshl_add_u32 v30, v6, 5, v30
    s_lshl_b32 s77, s73, 6
    v_xor_b32 v30, s77, v30
    v_add_u32 v30, 32768, v30
    v_xor_b32_e64 v31, 32, v30
    v_add_u32 v22, 16384, v30
    v_add_u32 v23, 16384, v31
    v_add_u32 v24, 81920, v30
    v_add_u32 v25, 81920, v31
    v_mov_b32 v178, 0x358637bd
    v_and_b32_e64 v6, 1, v5
    v_and_b32 v7, 0x70, v3
    v_lshlrev_b32 v6, 5, v6
    v_xor_b32 v7, v6, v7
    v_lshrrev_b32_e64 v6, 3, v0
    v_mul_u32_u24 v6, 3072, v6
    s_lshl_b32 s77, s69, 7
    v_add3_u32 v184, v6, s77, v7
    v_xor_b32 v185, 64, v184
    v_add_u32 v185, 23552, v185
    v_add_u32 v186, 47104, v184
    v_add_u32 v187, 47104, v185
    v_and_b32_e64 v6, 3, v5
    v_and_b32 v7, 0x70, v3
    v_lshlrev_b32 v6, 5, v6
    v_xor_b32 v7, v6, v7
    v_lshrrev_b32_e64 v6, 3, v0
    v_mul_u32_u24 v6, 1024, v6
    s_xor_b32 s77, s71, s42
    s_lshl_b32 s77, s77, 16
    s_lshl_b32 s78, s76, 7
    s_add_u32 s77, s77, s78
    v_add3_u32 v188, v6, s77, v7
    v_add_u32 v189, 7168, v188
    v_add_u32 v190, 14336, v188
    v_add_u32 v191, 14336, v189
    v_bfe_u32 v6, v0, 2, 2
    v_mad_u32_u24 v6, v5, 4, v6
    v_lshlrev_b32 v26, 7, v6
    v_and_b32 v6, 3, v0
    v_lshl_add_u32 v26, v6, 3, v26
    v_bfe_u32 v6, v0, 3, 2
    v_lshl_add_u32 v26, v6, 5, v26
    s_lshl_b32 s77, s73, 15
    s_add_u32 s77, s77, 98304
    v_add_u32 v26, s77, v26
    v_xor_b32 v27, 32, v26
    v_xor_b32 v28, 64, v26
    v_xor_b32 v29, 96, v26
    v_mov_b32 v176, 0x3fb8aa3b
    v_mov_b32 v177, 0xb5c1a2a0
    v_mov_b32 v180, 0x3f803f80
    v_mov_b32 v181, 0x3f803f80
    v_mov_b32 v182, 0x3f803f80
    v_mov_b32 v183, 0x3f803f80
    v_mov_b32 v140, v178
    v_mov_b32 v141, v178
    v_mov_b32 v142, v178
    v_mov_b32 v143, v178
    s_sub_u32 s94, 0, s72
    s_mov_b32 s95, s94
    s_mov_b32 s88, 0xaaaaaaaa
    s_mov_b32 s89, s88
    s_lshl_b32 s77, s73, 14
    v_add_u32 v37, s77, v3
    s_lshl_b32 s77, s68, 10
    v_add_u32 v35, s77, v37
    s_lshl_b32 s77, s72, 13
    v_add_u32 v37, s77, v37
    s_lshl_b32 s77, s73, 10
    s_add_u32 s77, s77, 32768
    v_lshl_add_u32 v7, v5, 4, s77
    v_add_u32 v36, s77, v3
    s_lshl_b32 s77, s68, 6
    v_add_u32_e64 v7, s77, v7
    v_lshl_or_b32 v7, v2, 24, v7
    v_cndmask_b32 v35, v35, v7, s[94:95]
    s_lshl_b32 s77, s71, 13
    v_add_u32 v38, s77, v3
    v_xor_b32 v39, 16384, v38
    s_lshl1_add_u32 s77, s69, s73
    s_and_b32 s77, s77, 7
    s_mul_i32 s78, s72, 96
    s_add_u32 s77, s77, s78
    s_add_u32 s77, s77, 16
    s_lshl_b32 s77, s77, 11
    s_add_u32 s87, s87, s77
    s_add_u32 s84, s87, 98304
    v_bfe_u32 v6, v0, 3, 1
    v_lshlrev_b32 v6, 1, v6
    v_xor_b32 v6, v6, v5
    v_lshl_add_u32 v33, v2, 3, s53
    v_lshl_add_u32 v32, v6, 9, v33
    v_lshl_add_u32 v252, v5, 4, s53
    v_lshl_add_u32 v253, v6, 4, s54
    v_lshlrev_b32_e64 v7, 4, v2
    v_lshl_add_u32 v179, v6, 16, v7
    v_and_b32_e64 v7, 0x30, v7
    v_lshl_or_b32 v7, v6, 6, v7
    v_lshrrev_b32_e64 v6, 2, v2
    v_lshl_or_b32 v7, v6, 10, v7
    v_add_u32 v4, s55, v7
    v_and_b32 v6, 14, v2
    v_xor_b32_e64 v6, v6, v5
    v_lshl_add_u32 v6, v6, 3, s58
    v_lshl_add_u32 v216, v2, 7, v6
    v_xor_b32 v217, 32, v216
    v_xor_b32 v218, 64, v216
    v_xor_b32 v219, 96, v216
    v_add_u32 v220, 0x10000, v216
    v_add_u32 v221, 0x10000, v217
    v_add_u32 v222, 0x10000, v218
    v_add_u32 v223, 0x10000, v219
    s_add_u32 m0, s83, 65536
    s_bfe_u32 s81, s3, 0x30004
    s_lshl_b32 s81, s81, 7
    s_nop 0
    buffer_load_dwordx4 v10, s[4:7], s81 offen lds
    buffer_load_dwordx4 v11, s[4:7], s81 offen offset:1024 lds
    buffer_load_dwordx4 v12, s[4:7], s81 offen offset:2048 lds
    buffer_load_dwordx4 v13, s[4:7], s81 offen offset:3072 lds
    s_add_u32 m0, s83, 81920
    s_mul_i32 s80, s81, s82
    buffer_load_dwordx4 v14, s[8:11], s80 offen lds
    buffer_load_dwordx4 v15, s[8:11], s80 offen offset:1024 lds
    buffer_load_dwordx4 v16, s[8:11], s80 offen offset:2048 lds
    buffer_load_dwordx4 v17, s[8:11], s80 offen offset:3072 lds
    s_waitcnt vmcnt(8)
    s_barrier
    s_nop 0
    ds_read_b128 a[0:3], v18 offset:0
    ds_read_b64_tr_b16 v[40:41], v22 offset:0
    ds_read_b64_tr_b16 v[42:43], v22 offset:512
    ds_read_b128 a[4:7], v19 offset:0
    ds_read_b64_tr_b16 v[44:45], v22 offset:4096
    ds_read_b64_tr_b16 v[46:47], v22 offset:4608
    ds_read_b128 a[8:11], v18 offset:256
    ds_read_b128 a[12:15], v19 offset:256
    ds_read_b128 a[16:19], v18 offset:512
    ds_read_b128 a[20:23], v19 offset:512
    ds_read_b128 a[24:27], v18 offset:768
    ds_read_b128 a[28:31], v19 offset:768
    s_waitcnt lgkmcnt(9)
    v_mfma_f32_16x16x32_bf16 v[72:75], a[0:3], v[40:43], v[140:143]
    ds_read_b64_tr_b16 v[48:49], v23 offset:0
    s_add_u32 m0, s83, 98304
    s_bfe_u32 s81, s3, 0x30008
    s_lshl_b32 s81, s81, 7
    buffer_load_dwordx4 v10, s[4:7], s81 offen lds
    s_waitcnt lgkmcnt(7)
    v_mfma_f32_16x16x32_bf16 v[72:75], a[4:7], v[44:47], v[72:75]
    ds_read_b64_tr_b16 v[50:51], v23 offset:512
    ds_read_b64_tr_b16 v[52:53], v23 offset:4096
    s_waitcnt lgkmcnt(8)
    v_mfma_f32_16x16x32_bf16 v[76:79], a[8:11], v[40:43], v[140:143]
    ds_read_b64_tr_b16 v[54:55], v23 offset:4608
    buffer_load_dwordx4 v11, s[4:7], s81 offen offset:1024 lds
    s_waitcnt lgkmcnt(8)
    v_mfma_f32_16x16x32_bf16 v[76:79], a[12:15], v[44:47], v[76:79]
    ds_read_b64_tr_b16 v[56:57], v22 offset:8192
    s_waitcnt lgkmcnt(8)
    v_mfma_f32_16x16x32_bf16 v[80:83], a[16:19], v[40:43], v[140:143]
    ds_read_b64_tr_b16 v[58:59], v22 offset:8704
    buffer_load_dwordx4 v12, s[4:7], s81 offen offset:2048 lds
    s_waitcnt lgkmcnt(8)
    v_mfma_f32_16x16x32_bf16 v[80:83], a[20:23], v[44:47], v[80:83]
    ds_read_b64_tr_b16 v[60:61], v22 offset:12288
    ds_read_b64_tr_b16 v[62:63], v22 offset:12800
    s_waitcnt lgkmcnt(9)
    v_mfma_f32_16x16x32_bf16 v[84:87], a[24:27], v[40:43], v[140:143]
    buffer_load_dwordx4 v13, s[4:7], s81 offen offset:3072 lds
    s_add_u32 m0, s83, 114688
    s_waitcnt lgkmcnt(8)
    v_mfma_f32_16x16x32_bf16 v[84:87], a[28:31], v[44:47], v[84:87]
    s_mul_i32 s80, s81, s82
    s_waitcnt lgkmcnt(6)
    v_mfma_f32_16x16x32_bf16 v[88:91], a[0:3], v[48:51], v[140:143]
    ds_read_b64_tr_b16 v[64:65], v23 offset:8192
    buffer_load_dwordx4 v14, s[8:11], s80 offen lds
    s_waitcnt lgkmcnt(5)
    v_mfma_f32_16x16x32_bf16 v[88:91], a[4:7], v[52:55], v[88:91]
    ds_read_b64_tr_b16 v[66:67], v23 offset:8704
    v_mfma_f32_16x16x32_bf16 v[92:95], a[8:11], v[48:51], v[140:143]
    ds_read_b64_tr_b16 v[68:69], v23 offset:12288
    buffer_load_dwordx4 v15, s[8:11], s80 offen offset:1024 lds
    v_mfma_f32_16x16x32_bf16 v[92:95], a[12:15], v[52:55], v[92:95]
    ds_read_b64_tr_b16 v[70:71], v23 offset:12800
    v_mfma_f32_16x16x32_bf16 v[96:99], a[16:19], v[48:51], v[140:143]
    buffer_load_dwordx4 v16, s[8:11], s80 offen offset:2048 lds
    v_mfma_f32_16x16x32_bf16 v[96:99], a[20:23], v[52:55], v[96:99]
    v_mfma_f32_16x16x32_bf16 v[100:103], a[24:27], v[48:51], v[140:143]
    buffer_load_dwordx4 v17, s[8:11], s80 offen offset:3072 lds
    v_mfma_f32_16x16x32_bf16 v[100:103], a[28:31], v[52:55], v[100:103]
    s_waitcnt lgkmcnt(4)
    v_mfma_f32_16x16x32_bf16 v[104:107], a[0:3], v[56:59], 0
    s_waitcnt vmcnt(8)
    s_barrier
    s_nop 0
    ds_read_b128 a[32:35], v18 offset:32768
    v_mfma_f32_16x16x32_bf16 v[104:107], a[4:7], v[60:63], v[104:107]
    ds_read_b64_tr_b16 v[40:41], v22 offset:32768
    s_add_u32 m0, s83, 131072
    v_mfma_f32_16x16x32_bf16 v[108:111], a[8:11], v[56:59], 0
    ds_read_b64_tr_b16 v[42:43], v22 offset:33280
    s_bfe_u32 s81, s3, 0x3000c
    s_lshl_b32 s81, s81, 7
    s_nop 0
    buffer_load_dwordx4 v10, s[4:7], s81 offen lds
    v_mfma_f32_16x16x32_bf16 v[108:111], a[12:15], v[60:63], v[108:111]
    ds_read_b128 a[36:39], v19 offset:32768
    v_mfma_f32_16x16x32_bf16 v[112:115], a[16:19], v[56:59], 0
    ds_read_b64_tr_b16 v[44:45], v22 offset:36864
    v_mfma_f32_16x16x32_bf16 v[112:115], a[20:23], v[60:63], v[112:115]
    ds_read_b64_tr_b16 v[46:47], v22 offset:37376
    v_mfma_f32_16x16x32_bf16 v[116:119], a[24:27], v[56:59], 0
    ds_read_b128 a[40:43], v18 offset:33024
    buffer_load_dwordx4 v11, s[4:7], s81 offen offset:1024 lds
    v_mfma_f32_16x16x32_bf16 v[116:119], a[28:31], v[60:63], v[116:119]
    ds_read_b128 a[44:47], v19 offset:33024
    s_waitcnt lgkmcnt(8)
    s_nop 0
    v_mfma_f32_16x16x32_bf16 v[120:123], a[0:3], v[64:67], 0
    ds_read_b128 a[48:51], v18 offset:33280
    v_mfma_f32_16x16x32_bf16 v[120:123], a[4:7], v[68:71], v[120:123]
    ds_read_b128 a[52:55], v19 offset:33280
    v_mfma_f32_16x16x32_bf16 v[124:127], a[8:11], v[64:67], 0
    ds_read_b128 a[56:59], v18 offset:33536
    buffer_load_dwordx4 v12, s[4:7], s81 offen offset:2048 lds
    v_mfma_f32_16x16x32_bf16 v[124:127], a[12:15], v[68:71], v[124:127]
    ds_read_b128 a[60:63], v19 offset:33536
    v_mfma_f32_16x16x32_bf16 v[128:131], a[16:19], v[64:67], 0
    ds_read_b64_tr_b16 v[48:49], v23 offset:32768
    ds_read_b64_tr_b16 v[50:51], v23 offset:33280
    v_mfma_f32_16x16x32_bf16 v[128:131], a[20:23], v[68:71], v[128:131]
    ds_read_b64_tr_b16 v[52:53], v23 offset:36864
    ds_read_b64_tr_b16 v[54:55], v23 offset:37376
    v_mfma_f32_16x16x32_bf16 v[132:135], a[24:27], v[64:67], 0
    buffer_load_dwordx4 v13, s[4:7], s81 offen offset:3072 lds
    s_add_u32 m0, s83, 147456
    v_mfma_f32_16x16x32_bf16 v[132:135], a[28:31], v[68:71], v[132:135]
    s_mul_i32 s80, s81, s82
    s_waitcnt lgkmcnt(10)
    v_mfma_f32_16x16x32_bf16 v[72:75], a[32:35], v[40:43], v[72:75]
    ds_read_b64_tr_b16 v[56:57], v22 offset:40960
    v_mfma_f32_16x16x32_bf16 v[72:75], a[36:39], v[44:47], v[72:75]
    ds_read_b64_tr_b16 v[58:59], v22 offset:41472
    s_waitcnt lgkmcnt(10)
    s_nop 0
    v_mfma_f32_16x16x32_bf16 v[76:79], a[40:43], v[40:43], v[76:79]
    ds_read_b64_tr_b16 v[60:61], v22 offset:45056
    buffer_load_dwordx4 v14, s[8:11], s80 offen lds
    v_mfma_f32_16x16x32_bf16 v[76:79], a[44:47], v[44:47], v[76:79]
    ds_read_b64_tr_b16 v[62:63], v22 offset:45568
    s_waitcnt lgkmcnt(10)
    v_mfma_f32_16x16x32_bf16 v[80:83], a[48:51], v[40:43], v[80:83]
    v_mfma_f32_16x16x32_bf16 v[80:83], a[52:55], v[44:47], v[80:83]
    s_waitcnt lgkmcnt(8)
    v_mfma_f32_16x16x32_bf16 v[84:87], a[56:59], v[40:43], v[84:87]
    buffer_load_dwordx4 v15, s[8:11], s80 offen offset:1024 lds
    v_mfma_f32_16x16x32_bf16 v[84:87], a[60:63], v[44:47], v[84:87]
    s_waitcnt lgkmcnt(4)
    s_nop 0
    v_mfma_f32_16x16x32_bf16 v[88:91], a[32:35], v[48:51], v[88:91]
    ds_read_b64_tr_b16 v[64:65], v23 offset:40960
    v_mfma_f32_16x16x32_bf16 v[88:91], a[36:39], v[52:55], v[88:91]
    ds_read_b64_tr_b16 v[66:67], v23 offset:41472
    v_mfma_f32_16x16x32_bf16 v[92:95], a[40:43], v[48:51], v[92:95]
    ds_read_b64_tr_b16 v[68:69], v23 offset:45056
    buffer_load_dwordx4 v16, s[8:11], s80 offen offset:2048 lds
    v_mfma_f32_16x16x32_bf16 v[92:95], a[44:47], v[52:55], v[92:95]
    ds_read_b64_tr_b16 v[70:71], v23 offset:45568
    v_mfma_f32_16x16x32_bf16 v[96:99], a[48:51], v[48:51], v[96:99]
    v_mfma_f32_16x16x32_bf16 v[96:99], a[52:55], v[52:55], v[96:99]
    v_mfma_f32_16x16x32_bf16 v[100:103], a[56:59], v[48:51], v[100:103]
    buffer_load_dwordx4 v17, s[8:11], s80 offen offset:3072 lds
    v_mfma_f32_16x16x32_bf16 v[100:103], a[60:63], v[52:55], v[100:103]
    s_waitcnt lgkmcnt(4)
    v_mfma_f32_16x16x32_bf16 v[104:107], a[32:35], v[56:59], v[104:107]
    s_waitcnt vmcnt(8)
    s_barrier
    s_nop 0
    ds_read_b128 a[64:67], v20 offset:0
    v_mfma_f32_16x16x32_bf16 v[104:107], a[36:39], v[60:63], v[104:107]
    ds_read_b64_tr_b16 v[40:41], v24 offset:0
    s_add_u32 m0, s83, 32768
    v_mfma_f32_16x16x32_bf16 v[108:111], a[40:43], v[56:59], v[108:111]
    ds_read_b64_tr_b16 v[42:43], v24 offset:512
    s_bfe_u32 s81, s3, 0x30010
    s_lshl_b32 s81, s81, 7
    s_nop 0
    buffer_load_dwordx4 v10, s[4:7], s81 offen lds
    v_mfma_f32_16x16x32_bf16 v[108:111], a[44:47], v[60:63], v[108:111]
    ds_read_b128 a[68:71], v21 offset:0
    v_mfma_f32_16x16x32_bf16 v[112:115], a[48:51], v[56:59], v[112:115]
    ds_read_b64_tr_b16 v[44:45], v24 offset:4096
    v_mfma_f32_16x16x32_bf16 v[112:115], a[52:55], v[60:63], v[112:115]
    ds_read_b64_tr_b16 v[46:47], v24 offset:4608
    v_mfma_f32_16x16x32_bf16 v[116:119], a[56:59], v[56:59], v[116:119]
    ds_read_b128 a[72:75], v20 offset:256
    buffer_load_dwordx4 v11, s[4:7], s81 offen offset:1024 lds
    v_mfma_f32_16x16x32_bf16 v[116:119], a[60:63], v[60:63], v[116:119]
    ds_read_b128 a[76:79], v21 offset:256
    s_waitcnt lgkmcnt(8)
    s_nop 0
    v_mfma_f32_16x16x32_bf16 v[120:123], a[32:35], v[64:67], v[120:123]
    ds_read_b128 a[80:83], v20 offset:512
    v_mfma_f32_16x16x32_bf16 v[120:123], a[36:39], v[68:71], v[120:123]
    ds_read_b128 a[84:87], v21 offset:512
    v_mfma_f32_16x16x32_bf16 v[124:127], a[40:43], v[64:67], v[124:127]
    ds_read_b128 a[88:91], v20 offset:768
    buffer_load_dwordx4 v12, s[4:7], s81 offen offset:2048 lds
    v_mfma_f32_16x16x32_bf16 v[124:127], a[44:47], v[68:71], v[124:127]
    ds_read_b128 a[92:95], v21 offset:768
    v_mfma_f32_16x16x32_bf16 v[128:131], a[48:51], v[64:67], v[128:131]
    ds_read_b64_tr_b16 v[48:49], v25 offset:0
    ds_read_b64_tr_b16 v[50:51], v25 offset:512
    v_mfma_f32_16x16x32_bf16 v[128:131], a[52:55], v[68:71], v[128:131]
    ds_read_b64_tr_b16 v[52:53], v25 offset:4096
    ds_read_b64_tr_b16 v[54:55], v25 offset:4608
    v_mfma_f32_16x16x32_bf16 v[132:135], a[56:59], v[64:67], v[132:135]
    buffer_load_dwordx4 v13, s[4:7], s81 offen offset:3072 lds
    s_add_u32 m0, s83, 49152
    v_mfma_f32_16x16x32_bf16 v[132:135], a[60:63], v[68:71], v[132:135]
    s_mul_i32 s80, s81, s82
    s_waitcnt lgkmcnt(10)
    v_mfma_f32_16x16x32_bf16 v[72:75], a[64:67], v[40:43], v[72:75]
    ds_read_b64_tr_b16 v[56:57], v24 offset:8192
    v_mfma_f32_16x16x32_bf16 v[72:75], a[68:71], v[44:47], v[72:75]
    ds_read_b64_tr_b16 v[58:59], v24 offset:8704
    s_waitcnt lgkmcnt(10)
    s_nop 0
    v_mfma_f32_16x16x32_bf16 v[76:79], a[72:75], v[40:43], v[76:79]
    ds_read_b64_tr_b16 v[60:61], v24 offset:12288
    buffer_load_dwordx4 v14, s[8:11], s80 offen lds
    v_mfma_f32_16x16x32_bf16 v[76:79], a[76:79], v[44:47], v[76:79]
    ds_read_b64_tr_b16 v[62:63], v24 offset:12800
    s_waitcnt lgkmcnt(10)
    v_mfma_f32_16x16x32_bf16 v[80:83], a[80:83], v[40:43], v[80:83]
    v_mfma_f32_16x16x32_bf16 v[80:83], a[84:87], v[44:47], v[80:83]
    s_waitcnt lgkmcnt(8)
    v_mfma_f32_16x16x32_bf16 v[84:87], a[88:91], v[40:43], v[84:87]
    buffer_load_dwordx4 v15, s[8:11], s80 offen offset:1024 lds
    v_mfma_f32_16x16x32_bf16 v[84:87], a[92:95], v[44:47], v[84:87]
    s_waitcnt lgkmcnt(4)
    s_nop 0
    v_mfma_f32_16x16x32_bf16 v[88:91], a[64:67], v[48:51], v[88:91]
    ds_read_b64_tr_b16 v[64:65], v25 offset:8192
    v_mfma_f32_16x16x32_bf16 v[88:91], a[68:71], v[52:55], v[88:91]
    ds_read_b64_tr_b16 v[66:67], v25 offset:8704
    v_mfma_f32_16x16x32_bf16 v[92:95], a[72:75], v[48:51], v[92:95]
    ds_read_b64_tr_b16 v[68:69], v25 offset:12288
    buffer_load_dwordx4 v16, s[8:11], s80 offen offset:2048 lds
    v_mfma_f32_16x16x32_bf16 v[92:95], a[76:79], v[52:55], v[92:95]
    ds_read_b64_tr_b16 v[70:71], v25 offset:12800
    v_mfma_f32_16x16x32_bf16 v[96:99], a[80:83], v[48:51], v[96:99]
    v_mfma_f32_16x16x32_bf16 v[96:99], a[84:87], v[52:55], v[96:99]
    v_mfma_f32_16x16x32_bf16 v[100:103], a[88:91], v[48:51], v[100:103]
    buffer_load_dwordx4 v17, s[8:11], s80 offen offset:3072 lds
    v_mfma_f32_16x16x32_bf16 v[100:103], a[92:95], v[52:55], v[100:103]
    s_waitcnt lgkmcnt(4)
    v_mfma_f32_16x16x32_bf16 v[104:107], a[64:67], v[56:59], v[104:107]
    s_waitcnt vmcnt(8)
    s_barrier
    s_nop 0
    ds_read_b128 a[96:99], v20 offset:32768
    v_mfma_f32_16x16x32_bf16 v[104:107], a[68:71], v[60:63], v[104:107]
    ds_read_b64_tr_b16 v[40:41], v24 offset:32768
    s_add_u32 m0, s83, 65536
    v_mfma_f32_16x16x32_bf16 v[108:111], a[72:75], v[56:59], v[108:111]
    ds_read_b64_tr_b16 v[42:43], v24 offset:33280
    s_bfe_u32 s81, s3, 0x30014
    s_lshl_b32 s81, s81, 7
    s_nop 0
    buffer_load_dwordx4 v10, s[4:7], s81 offen lds
    v_mfma_f32_16x16x32_bf16 v[108:111], a[76:79], v[60:63], v[108:111]
    ds_read_b128 a[100:103], v21 offset:32768
    v_mfma_f32_16x16x32_bf16 v[112:115], a[80:83], v[56:59], v[112:115]
    ds_read_b64_tr_b16 v[44:45], v24 offset:36864
    v_mfma_f32_16x16x32_bf16 v[112:115], a[84:87], v[60:63], v[112:115]
    ds_read_b64_tr_b16 v[46:47], v24 offset:37376
    v_mfma_f32_16x16x32_bf16 v[116:119], a[88:91], v[56:59], v[116:119]
    ds_read_b128 a[104:107], v20 offset:33024
    buffer_load_dwordx4 v11, s[4:7], s81 offen offset:1024 lds
    v_mfma_f32_16x16x32_bf16 v[116:119], a[92:95], v[60:63], v[116:119]
    ds_read_b128 a[108:111], v21 offset:33024
    s_waitcnt lgkmcnt(8)
    s_nop 0
    v_mfma_f32_16x16x32_bf16 v[120:123], a[64:67], v[64:67], v[120:123]
    ds_read_b128 a[112:115], v20 offset:33280
    v_mfma_f32_16x16x32_bf16 v[120:123], a[68:71], v[68:71], v[120:123]
    ds_read_b128 a[116:119], v21 offset:33280
    v_mfma_f32_16x16x32_bf16 v[124:127], a[72:75], v[64:67], v[124:127]
    ds_read_b128 a[120:123], v20 offset:33536
    buffer_load_dwordx4 v12, s[4:7], s81 offen offset:2048 lds
    v_mfma_f32_16x16x32_bf16 v[124:127], a[76:79], v[68:71], v[124:127]
    ds_read_b128 a[124:127], v21 offset:33536
    v_mfma_f32_16x16x32_bf16 v[128:131], a[80:83], v[64:67], v[128:131]
    ds_read_b64_tr_b16 v[48:49], v25 offset:32768
    ds_read_b64_tr_b16 v[50:51], v25 offset:33280
    v_mfma_f32_16x16x32_bf16 v[128:131], a[84:87], v[68:71], v[128:131]
    ds_read_b64_tr_b16 v[52:53], v25 offset:36864
    ds_read_b64_tr_b16 v[54:55], v25 offset:37376
    v_mfma_f32_16x16x32_bf16 v[132:135], a[88:91], v[64:67], v[132:135]
    buffer_load_dwordx4 v13, s[4:7], s81 offen offset:3072 lds
    s_add_u32 m0, s83, 81920
    v_mfma_f32_16x16x32_bf16 v[132:135], a[92:95], v[68:71], v[132:135]
    s_mul_i32 s80, s81, s82
    s_waitcnt lgkmcnt(10)
    v_mfma_f32_16x16x32_bf16 v[72:75], a[96:99], v[40:43], v[72:75]
    ds_read_b64_tr_b16 v[56:57], v24 offset:40960
    v_mfma_f32_16x16x32_bf16 v[72:75], a[100:103], v[44:47], v[72:75]
    ds_read_b64_tr_b16 v[58:59], v24 offset:41472
    s_waitcnt lgkmcnt(10)
    s_nop 0
    v_mfma_f32_16x16x32_bf16 v[76:79], a[104:107], v[40:43], v[76:79]
    ds_read_b64_tr_b16 v[60:61], v24 offset:45056
    buffer_load_dwordx4 v14, s[8:11], s80 offen lds
    v_mfma_f32_16x16x32_bf16 v[76:79], a[108:111], v[44:47], v[76:79]
    ds_read_b64_tr_b16 v[62:63], v24 offset:45568
    s_waitcnt lgkmcnt(10)
    v_mfma_f32_16x16x32_bf16 v[80:83], a[112:115], v[40:43], v[80:83]
    v_mfma_f32_16x16x32_bf16 v[80:83], a[116:119], v[44:47], v[80:83]
    s_waitcnt lgkmcnt(8)
    v_mfma_f32_16x16x32_bf16 v[84:87], a[120:123], v[40:43], v[84:87]
    buffer_load_dwordx4 v15, s[8:11], s80 offen offset:1024 lds
    v_mfma_f32_16x16x32_bf16 v[84:87], a[124:127], v[44:47], v[84:87]
    s_waitcnt lgkmcnt(4)
    s_nop 0
    v_mfma_f32_16x16x32_bf16 v[88:91], a[96:99], v[48:51], v[88:91]
    ds_read_b64_tr_b16 v[64:65], v25 offset:40960
    v_mfma_f32_16x16x32_bf16 v[88:91], a[100:103], v[52:55], v[88:91]
    ds_read_b64_tr_b16 v[66:67], v25 offset:41472
    v_mfma_f32_16x16x32_bf16 v[92:95], a[104:107], v[48:51], v[92:95]
    ds_read_b64_tr_b16 v[68:69], v25 offset:45056
    buffer_load_dwordx4 v16, s[8:11], s80 offen offset:2048 lds
    v_mfma_f32_16x16x32_bf16 v[92:95], a[108:111], v[52:55], v[92:95]
    ds_read_b64_tr_b16 v[70:71], v25 offset:45568
    v_mfma_f32_16x16x32_bf16 v[96:99], a[112:115], v[48:51], v[96:99]
    v_mfma_f32_16x16x32_bf16 v[96:99], a[116:119], v[52:55], v[96:99]
    v_mfma_f32_16x16x32_bf16 v[100:103], a[120:123], v[48:51], v[100:103]
    buffer_load_dwordx4 v17, s[8:11], s80 offen offset:3072 lds
    v_mfma_f32_16x16x32_bf16 v[100:103], a[124:127], v[52:55], v[100:103]
    s_waitcnt lgkmcnt(4)
    v_mfma_f32_16x16x32_bf16 v[104:107], a[96:99], v[56:59], v[104:107]
    s_waitcnt vmcnt(8)
    s_barrier
    s_nop 0
    ds_read_b128 a[128:131], v18 offset:0
    v_mfma_f32_16x16x32_bf16 v[104:107], a[100:103], v[60:63], v[104:107]
    ds_read_b64_tr_b16 v[40:41], v22 offset:0
    s_add_u32 m0, s83, 98304
    v_mfma_f32_16x16x32_bf16 v[108:111], a[104:107], v[56:59], v[108:111]
    ds_read_b64_tr_b16 v[42:43], v22 offset:512
    s_bfe_u32 s81, s3, 0x30018
    s_lshl_b32 s81, s81, 7
    s_nop 0
    buffer_load_dwordx4 v10, s[4:7], s81 offen lds
    v_mfma_f32_16x16x32_bf16 v[108:111], a[108:111], v[60:63], v[108:111]
    ds_read_b128 a[132:135], v19 offset:0
    v_mfma_f32_16x16x32_bf16 v[112:115], a[112:115], v[56:59], v[112:115]
    ds_read_b64_tr_b16 v[44:45], v22 offset:4096
    v_mfma_f32_16x16x32_bf16 v[112:115], a[116:119], v[60:63], v[112:115]
    ds_read_b64_tr_b16 v[46:47], v22 offset:4608
    v_mfma_f32_16x16x32_bf16 v[116:119], a[120:123], v[56:59], v[116:119]
    ds_read_b128 a[136:139], v18 offset:256
    buffer_load_dwordx4 v11, s[4:7], s81 offen offset:1024 lds
    v_mfma_f32_16x16x32_bf16 v[116:119], a[124:127], v[60:63], v[116:119]
    ds_read_b128 a[140:143], v19 offset:256
    s_waitcnt lgkmcnt(8)
    s_nop 0
    v_mfma_f32_16x16x32_bf16 v[120:123], a[96:99], v[64:67], v[120:123]
    ds_read_b128 a[144:147], v18 offset:512
    v_mfma_f32_16x16x32_bf16 v[120:123], a[100:103], v[68:71], v[120:123]
    ds_read_b128 a[148:151], v19 offset:512
    v_mfma_f32_16x16x32_bf16 v[124:127], a[104:107], v[64:67], v[124:127]
    ds_read_b128 a[152:155], v18 offset:768
    buffer_load_dwordx4 v12, s[4:7], s81 offen offset:2048 lds
    v_mfma_f32_16x16x32_bf16 v[124:127], a[108:111], v[68:71], v[124:127]
    ds_read_b128 a[156:159], v19 offset:768
    v_mfma_f32_16x16x32_bf16 v[128:131], a[112:115], v[64:67], v[128:131]
    ds_read_b64_tr_b16 v[48:49], v23 offset:0
    ds_read_b64_tr_b16 v[50:51], v23 offset:512
    v_mfma_f32_16x16x32_bf16 v[128:131], a[116:119], v[68:71], v[128:131]
    ds_read_b64_tr_b16 v[52:53], v23 offset:4096
    ds_read_b64_tr_b16 v[54:55], v23 offset:4608
    v_mfma_f32_16x16x32_bf16 v[132:135], a[120:123], v[64:67], v[132:135]
    buffer_load_dwordx4 v13, s[4:7], s81 offen offset:3072 lds
    s_add_u32 m0, s83, 114688
    v_mfma_f32_16x16x32_bf16 v[132:135], a[124:127], v[68:71], v[132:135]
    s_mul_i32 s80, s81, s82
    s_waitcnt lgkmcnt(10)
    v_mfma_f32_16x16x32_bf16 v[72:75], a[128:131], v[40:43], v[72:75]
    ds_read_b64_tr_b16 v[56:57], v22 offset:8192
    v_mfma_f32_16x16x32_bf16 v[72:75], a[132:135], v[44:47], v[72:75]
    ds_read_b64_tr_b16 v[58:59], v22 offset:8704
    s_waitcnt lgkmcnt(10)
    s_nop 0
    v_mfma_f32_16x16x32_bf16 v[76:79], a[136:139], v[40:43], v[76:79]
    ds_read_b64_tr_b16 v[60:61], v22 offset:12288
    buffer_load_dwordx4 v14, s[8:11], s80 offen lds
    v_mfma_f32_16x16x32_bf16 v[76:79], a[140:143], v[44:47], v[76:79]
    ds_read_b64_tr_b16 v[62:63], v22 offset:12800
    s_waitcnt lgkmcnt(10)
    v_mfma_f32_16x16x32_bf16 v[80:83], a[144:147], v[40:43], v[80:83]
    v_mfma_f32_16x16x32_bf16 v[80:83], a[148:151], v[44:47], v[80:83]
    s_waitcnt lgkmcnt(8)
    v_mfma_f32_16x16x32_bf16 v[84:87], a[152:155], v[40:43], v[84:87]
    buffer_load_dwordx4 v15, s[8:11], s80 offen offset:1024 lds
    v_mfma_f32_16x16x32_bf16 v[84:87], a[156:159], v[44:47], v[84:87]
    s_waitcnt lgkmcnt(4)
    s_nop 0
    v_mfma_f32_16x16x32_bf16 v[88:91], a[128:131], v[48:51], v[88:91]
    ds_read_b64_tr_b16 v[64:65], v23 offset:8192
    v_mfma_f32_16x16x32_bf16 v[88:91], a[132:135], v[52:55], v[88:91]
    ds_read_b64_tr_b16 v[66:67], v23 offset:8704
    v_mfma_f32_16x16x32_bf16 v[92:95], a[136:139], v[48:51], v[92:95]
    ds_read_b64_tr_b16 v[68:69], v23 offset:12288
    buffer_load_dwordx4 v16, s[8:11], s80 offen offset:2048 lds
    v_mfma_f32_16x16x32_bf16 v[92:95], a[140:143], v[52:55], v[92:95]
    ds_read_b64_tr_b16 v[70:71], v23 offset:12800
    v_mfma_f32_16x16x32_bf16 v[96:99], a[144:147], v[48:51], v[96:99]
    v_mfma_f32_16x16x32_bf16 v[96:99], a[148:151], v[52:55], v[96:99]
    v_mfma_f32_16x16x32_bf16 v[100:103], a[152:155], v[48:51], v[100:103]
    buffer_load_dwordx4 v17, s[8:11], s80 offen offset:3072 lds
    v_mfma_f32_16x16x32_bf16 v[100:103], a[156:159], v[52:55], v[100:103]
    s_waitcnt lgkmcnt(4)
    v_mfma_f32_16x16x32_bf16 v[104:107], a[128:131], v[56:59], v[104:107]
    s_waitcnt vmcnt(8)
    s_barrier
    s_nop 0
    ds_read_b128 a[160:163], v18 offset:32768
    v_mfma_f32_16x16x32_bf16 v[104:107], a[132:135], v[60:63], v[104:107]
    ds_read_b64_tr_b16 v[40:41], v22 offset:32768
    s_add_u32 m0, s83, 131072
    v_mfma_f32_16x16x32_bf16 v[108:111], a[136:139], v[56:59], v[108:111]
    ds_read_b64_tr_b16 v[42:43], v22 offset:33280
    s_bfe_u32 s81, s3, 0x3001c
    s_lshl_b32 s81, s81, 7
    s_nop 0
    buffer_load_dwordx4 v10, s[4:7], s81 offen lds
    v_mfma_f32_16x16x32_bf16 v[108:111], a[140:143], v[60:63], v[108:111]
    ds_read_b128 a[164:167], v19 offset:32768
    v_mfma_f32_16x16x32_bf16 v[112:115], a[144:147], v[56:59], v[112:115]
    ds_read_b64_tr_b16 v[44:45], v22 offset:36864
    v_mfma_f32_16x16x32_bf16 v[112:115], a[148:151], v[60:63], v[112:115]
    ds_read_b64_tr_b16 v[46:47], v22 offset:37376
    v_mfma_f32_16x16x32_bf16 v[116:119], a[152:155], v[56:59], v[116:119]
    ds_read_b128 a[168:171], v18 offset:33024
    buffer_load_dwordx4 v11, s[4:7], s81 offen offset:1024 lds
    v_mfma_f32_16x16x32_bf16 v[116:119], a[156:159], v[60:63], v[116:119]
    ds_read_b128 a[172:175], v19 offset:33024
    s_waitcnt lgkmcnt(8)
    s_nop 0
    v_mfma_f32_16x16x32_bf16 v[120:123], a[128:131], v[64:67], v[120:123]
    ds_read_b128 a[176:179], v18 offset:33280
    v_mfma_f32_16x16x32_bf16 v[120:123], a[132:135], v[68:71], v[120:123]
    ds_read_b128 a[180:183], v19 offset:33280
    v_mfma_f32_16x16x32_bf16 v[124:127], a[136:139], v[64:67], v[124:127]
    ds_read_b128 a[184:187], v18 offset:33536
    buffer_load_dwordx4 v12, s[4:7], s81 offen offset:2048 lds
    v_mfma_f32_16x16x32_bf16 v[124:127], a[140:143], v[68:71], v[124:127]
    ds_read_b128 a[188:191], v19 offset:33536
    v_mfma_f32_16x16x32_bf16 v[128:131], a[144:147], v[64:67], v[128:131]
    ds_read_b64_tr_b16 v[48:49], v23 offset:32768
    ds_read_b64_tr_b16 v[50:51], v23 offset:33280
    v_mfma_f32_16x16x32_bf16 v[128:131], a[148:151], v[68:71], v[128:131]
    ds_read_b64_tr_b16 v[52:53], v23 offset:36864
    ds_read_b64_tr_b16 v[54:55], v23 offset:37376
    v_mfma_f32_16x16x32_bf16 v[132:135], a[152:155], v[64:67], v[132:135]
    buffer_load_dwordx4 v13, s[4:7], s81 offen offset:3072 lds
    s_add_u32 m0, s83, 147456
    v_mfma_f32_16x16x32_bf16 v[132:135], a[156:159], v[68:71], v[132:135]
    s_mul_i32 s80, s81, s82
    s_waitcnt lgkmcnt(10)
    v_mfma_f32_16x16x32_bf16 v[72:75], a[160:163], v[40:43], v[72:75]
    ds_read_b64_tr_b16 v[56:57], v22 offset:40960
    v_mfma_f32_16x16x32_bf16 v[72:75], a[164:167], v[44:47], v[72:75]
    ds_read_b64_tr_b16 v[58:59], v22 offset:41472
    s_waitcnt lgkmcnt(10)
    s_nop 0
    v_mfma_f32_16x16x32_bf16 v[76:79], a[168:171], v[40:43], v[76:79]
    ds_read_b64_tr_b16 v[60:61], v22 offset:45056
    buffer_load_dwordx4 v14, s[8:11], s80 offen lds
    v_mfma_f32_16x16x32_bf16 v[76:79], a[172:175], v[44:47], v[76:79]
    ds_read_b64_tr_b16 v[62:63], v22 offset:45568
    s_waitcnt lgkmcnt(10)
    v_mfma_f32_16x16x32_bf16 v[80:83], a[176:179], v[40:43], v[80:83]
    v_mfma_f32_16x16x32_bf16 v[80:83], a[180:183], v[44:47], v[80:83]
    s_waitcnt lgkmcnt(8)
    v_mfma_f32_16x16x32_bf16 v[84:87], a[184:187], v[40:43], v[84:87]
    buffer_load_dwordx4 v15, s[8:11], s80 offen offset:1024 lds
    v_mfma_f32_16x16x32_bf16 v[84:87], a[188:191], v[44:47], v[84:87]
    s_waitcnt lgkmcnt(4)
    s_nop 0
    v_mfma_f32_16x16x32_bf16 v[88:91], a[160:163], v[48:51], v[88:91]
    ds_read_b64_tr_b16 v[64:65], v23 offset:40960
    v_mfma_f32_16x16x32_bf16 v[88:91], a[164:167], v[52:55], v[88:91]
    ds_read_b64_tr_b16 v[66:67], v23 offset:41472
    v_mfma_f32_16x16x32_bf16 v[92:95], a[168:171], v[48:51], v[92:95]
    ds_read_b64_tr_b16 v[68:69], v23 offset:45056
    buffer_load_dwordx4 v16, s[8:11], s80 offen offset:2048 lds
    v_mfma_f32_16x16x32_bf16 v[92:95], a[172:175], v[52:55], v[92:95]
    ds_read_b64_tr_b16 v[70:71], v23 offset:45568
    v_mfma_f32_16x16x32_bf16 v[96:99], a[176:179], v[48:51], v[96:99]
    v_mfma_f32_16x16x32_bf16 v[96:99], a[180:183], v[52:55], v[96:99]
    v_mfma_f32_16x16x32_bf16 v[100:103], a[184:187], v[48:51], v[100:103]
    buffer_load_dwordx4 v17, s[8:11], s80 offen offset:3072 lds
    v_mfma_f32_16x16x32_bf16 v[100:103], a[188:191], v[52:55], v[100:103]
    s_waitcnt lgkmcnt(4)
    v_mfma_f32_16x16x32_bf16 v[104:107], a[160:163], v[56:59], v[104:107]
    s_waitcnt vmcnt(8)
    s_barrier
    s_nop 0
    global_load_dword v34, v34, s[64:65] sc1
    ds_read_b128 a[192:195], v20 offset:0
    v_mfma_f32_16x16x32_bf16 v[104:107], a[164:167], v[60:63], v[104:107]
    ds_read_b64_tr_b16 v[40:41], v24 offset:0
    s_lshl1_add_u32 m0, s83, 32768
    v_mfma_f32_16x16x32_bf16 v[108:111], a[168:171], v[56:59], v[108:111]
    ds_read_b64_tr_b16 v[42:43], v24 offset:512
    s_lshl2_add_u32 s79, s71, 0x30000
    s_bfe_u32 s79, s3, s79
    s_nop 0
    s_mul_i32 s80, s79, 196608
    buffer_load_dwordx4 v184, s[8:11], s80 offen lds
    v_mfma_f32_16x16x32_bf16 v[108:111], a[172:175], v[60:63], v[108:111]
    ds_read_b128 a[196:199], v21 offset:0
    v_mfma_f32_16x16x32_bf16 v[112:115], a[176:179], v[56:59], v[112:115]
    ds_read_b64_tr_b16 v[44:45], v24 offset:4096
    v_mfma_f32_16x16x32_bf16 v[112:115], a[180:183], v[60:63], v[112:115]
    ds_read_b64_tr_b16 v[46:47], v24 offset:4608
    v_mfma_f32_16x16x32_bf16 v[116:119], a[184:187], v[56:59], v[116:119]
    ds_read_b128 a[200:203], v20 offset:256
    buffer_load_dwordx4 v185, s[8:11], s80 offen offset:1024 lds
    v_mfma_f32_16x16x32_bf16 v[116:119], a[188:191], v[60:63], v[116:119]
    ds_read_b128 a[204:207], v21 offset:256
    s_waitcnt lgkmcnt(8)
    s_nop 0
    v_mfma_f32_16x16x32_bf16 v[120:123], a[160:163], v[64:67], v[120:123]
    ds_read_b128 a[208:211], v20 offset:512
    v_mfma_f32_16x16x32_bf16 v[120:123], a[164:167], v[68:71], v[120:123]
    ds_read_b128 a[212:215], v21 offset:512
    v_mfma_f32_16x16x32_bf16 v[124:127], a[168:171], v[64:67], v[124:127]
    ds_read_b128 a[216:219], v20 offset:768
    buffer_load_dwordx4 v186, s[8:11], s80 offen offset:2048 lds
    v_mfma_f32_16x16x32_bf16 v[124:127], a[172:175], v[68:71], v[124:127]
    ds_read_b128 a[220:223], v21 offset:768
    v_mfma_f32_16x16x32_bf16 v[128:131], a[176:179], v[64:67], v[128:131]
    ds_read_b64_tr_b16 v[48:49], v25 offset:0
    ds_read_b64_tr_b16 v[50:51], v25 offset:512
    v_mfma_f32_16x16x32_bf16 v[128:131], a[180:183], v[68:71], v[128:131]
    ds_read_b64_tr_b16 v[52:53], v25 offset:4096
    ds_read_b64_tr_b16 v[54:55], v25 offset:4608
    v_mfma_f32_16x16x32_bf16 v[132:135], a[184:187], v[64:67], v[132:135]
    buffer_load_dwordx4 v187, s[8:11], s80 offen offset:3072 lds
    s_add_u32 m0, m0, 4096
    v_mfma_f32_16x16x32_bf16 v[132:135], a[188:191], v[68:71], v[132:135]
    s_add_u32 s80, s80, 98304
    s_waitcnt lgkmcnt(10)
    v_mfma_f32_16x16x32_bf16 v[72:75], a[192:195], v[40:43], v[72:75]
    ds_read_b64_tr_b16 v[56:57], v24 offset:8192
    v_mfma_f32_16x16x32_bf16 v[72:75], a[196:199], v[44:47], v[72:75]
    ds_read_b64_tr_b16 v[58:59], v24 offset:8704
    s_waitcnt lgkmcnt(10)
    v_mfma_f32_16x16x32_bf16 v[76:79], a[200:203], v[40:43], v[76:79]
    ds_read_b64_tr_b16 v[60:61], v24 offset:12288
    buffer_load_dwordx4 v184, s[8:11], s80 offen lds
    v_mfma_f32_16x16x32_bf16 v[76:79], a[204:207], v[44:47], v[76:79]
    ds_read_b64_tr_b16 v[62:63], v24 offset:12800
    s_waitcnt lgkmcnt(10)
    v_mfma_f32_16x16x32_bf16 v[80:83], a[208:211], v[40:43], v[80:83]
    v_mfma_f32_16x16x32_bf16 v[80:83], a[212:215], v[44:47], v[80:83]
    s_waitcnt lgkmcnt(8)
    v_mfma_f32_16x16x32_bf16 v[84:87], a[216:219], v[40:43], v[84:87]
    buffer_load_dwordx4 v185, s[8:11], s80 offen offset:1024 lds
    v_mfma_f32_16x16x32_bf16 v[84:87], a[220:223], v[44:47], v[84:87]
    s_waitcnt lgkmcnt(4)
    s_nop 0
    v_mfma_f32_16x16x32_bf16 v[88:91], a[192:195], v[48:51], v[88:91]
    ds_read_b64_tr_b16 v[64:65], v25 offset:8192
    v_mfma_f32_16x16x32_bf16 v[88:91], a[196:199], v[52:55], v[88:91]
    ds_read_b64_tr_b16 v[66:67], v25 offset:8704
    v_mfma_f32_16x16x32_bf16 v[92:95], a[200:203], v[48:51], v[92:95]
    ds_read_b64_tr_b16 v[68:69], v25 offset:12288
    buffer_load_dwordx4 v186, s[8:11], s80 offen offset:2048 lds
    v_mfma_f32_16x16x32_bf16 v[92:95], a[204:207], v[52:55], v[92:95]
    ds_read_b64_tr_b16 v[70:71], v25 offset:12800
    v_mfma_f32_16x16x32_bf16 v[96:99], a[208:211], v[48:51], v[96:99]
    v_mfma_f32_16x16x32_bf16 v[96:99], a[212:215], v[52:55], v[96:99]
    v_mfma_f32_16x16x32_bf16 v[100:103], a[216:219], v[48:51], v[100:103]
    buffer_load_dwordx4 v187, s[8:11], s80 offen offset:3072 lds
    v_mfma_f32_16x16x32_bf16 v[100:103], a[220:223], v[52:55], v[100:103]
    s_waitcnt lgkmcnt(4)
    v_mfma_f32_16x16x32_bf16 v[104:107], a[192:195], v[56:59], v[104:107]
    s_waitcnt vmcnt(9)
    s_barrier
    s_nop 0
    ds_read_b128 a[224:227], v20 offset:32768
    v_mfma_f32_16x16x32_bf16 v[104:107], a[196:199], v[60:63], v[104:107]
    ds_read_b64_tr_b16 v[40:41], v24 offset:32768
    s_lshl1_add_u32 m0, s83, 65536
    v_mfma_f32_16x16x32_bf16 v[108:111], a[200:203], v[56:59], v[108:111]
    ds_read_b64_tr_b16 v[42:43], v24 offset:33280
    s_lshl2_add_u32 s79, s71, 0x30010
    s_bfe_u32 s79, s3, s79
    s_nop 0
    s_mul_i32 s80, s79, 196608
    buffer_load_dwordx4 v184, s[8:11], s80 offen lds
    v_mfma_f32_16x16x32_bf16 v[108:111], a[204:207], v[60:63], v[108:111]
    ds_read_b128 a[228:231], v21 offset:32768
    v_mfma_f32_16x16x32_bf16 v[112:115], a[208:211], v[56:59], v[112:115]
    ds_read_b64_tr_b16 v[44:45], v24 offset:36864
    v_mfma_f32_16x16x32_bf16 v[112:115], a[212:215], v[60:63], v[112:115]
    ds_read_b64_tr_b16 v[46:47], v24 offset:37376
    v_mfma_f32_16x16x32_bf16 v[116:119], a[216:219], v[56:59], v[116:119]
    ds_read_b128 a[232:235], v20 offset:33024
    buffer_load_dwordx4 v185, s[8:11], s80 offen offset:1024 lds
    v_mfma_f32_16x16x32_bf16 v[116:119], a[220:223], v[60:63], v[116:119]
    ds_read_b128 a[236:239], v21 offset:33024
    s_waitcnt lgkmcnt(8)
    s_nop 0
    v_mfma_f32_16x16x32_bf16 v[120:123], a[192:195], v[64:67], v[120:123]
    ds_read_b128 a[240:243], v20 offset:33280
    v_mfma_f32_16x16x32_bf16 v[120:123], a[196:199], v[68:71], v[120:123]
    ds_read_b128 a[244:247], v21 offset:33280
    v_mfma_f32_16x16x32_bf16 v[124:127], a[200:203], v[64:67], v[124:127]
    ds_read_b128 a[248:251], v20 offset:33536
    buffer_load_dwordx4 v186, s[8:11], s80 offen offset:2048 lds
    v_mfma_f32_16x16x32_bf16 v[124:127], a[204:207], v[68:71], v[124:127]
    ds_read_b128 a[252:255], v21 offset:33536
    v_mfma_f32_16x16x32_bf16 v[128:131], a[208:211], v[64:67], v[128:131]
    ds_read_b64_tr_b16 v[48:49], v25 offset:32768
    ds_read_b64_tr_b16 v[50:51], v25 offset:33280
    v_mfma_f32_16x16x32_bf16 v[128:131], a[212:215], v[68:71], v[128:131]
    ds_read_b64_tr_b16 v[52:53], v25 offset:36864
    ds_read_b64_tr_b16 v[54:55], v25 offset:37376
    v_mfma_f32_16x16x32_bf16 v[132:135], a[216:219], v[64:67], v[132:135]
    buffer_load_dwordx4 v187, s[8:11], s80 offen offset:3072 lds
    s_add_u32 m0, m0, 4096
    v_mfma_f32_16x16x32_bf16 v[132:135], a[220:223], v[68:71], v[132:135]
    s_add_u32 s80, s80, 98304
    s_waitcnt lgkmcnt(10)
    v_mfma_f32_16x16x32_bf16 v[72:75], a[224:227], v[40:43], v[72:75]
    ds_read_b64_tr_b16 v[56:57], v24 offset:40960
    v_mfma_f32_16x16x32_bf16 v[72:75], a[228:231], v[44:47], v[72:75]
    ds_read_b64_tr_b16 v[58:59], v24 offset:41472
    s_waitcnt lgkmcnt(10)
    v_mfma_f32_16x16x32_bf16 v[76:79], a[232:235], v[40:43], v[76:79]
    ds_read_b64_tr_b16 v[60:61], v24 offset:45056
    buffer_load_dwordx4 v184, s[8:11], s80 offen lds
    v_mfma_f32_16x16x32_bf16 v[76:79], a[236:239], v[44:47], v[76:79]
    ds_read_b64_tr_b16 v[62:63], v24 offset:45568
    s_waitcnt lgkmcnt(10)
    v_mfma_f32_16x16x32_bf16 v[80:83], a[240:243], v[40:43], v[80:83]
    v_mfma_f32_16x16x32_bf16 v[80:83], a[244:247], v[44:47], v[80:83]
    s_waitcnt lgkmcnt(8)
    v_mfma_f32_16x16x32_bf16 v[84:87], a[248:251], v[40:43], v[84:87]
    buffer_load_dwordx4 v185, s[8:11], s80 offen offset:1024 lds
    v_mfma_f32_16x16x32_bf16 v[84:87], a[252:255], v[44:47], v[84:87]
    s_waitcnt lgkmcnt(4)
    s_nop 0
    v_mfma_f32_16x16x32_bf16 v[88:91], a[224:227], v[48:51], v[88:91]
    ds_read_b64_tr_b16 v[64:65], v25 offset:40960
    v_mfma_f32_16x16x32_bf16 v[88:91], a[228:231], v[52:55], v[88:91]
    ds_read_b64_tr_b16 v[66:67], v25 offset:41472
    v_fma_f32 v240, v72, v176, v177
    v_fma_f32 v241, v73, v176, v177
    v_fma_f32 v242, v74, v176, v177
    v_fma_f32 v243, v75, v176, v177
    v_mfma_f32_16x16x32_bf16 v[92:95], a[232:235], v[48:51], v[92:95]
    ds_read_b64_tr_b16 v[68:69], v25 offset:45056
    buffer_load_dwordx4 v186, s[8:11], s80 offen offset:2048 lds
    v_exp_f32 v240, v240 clamp
    v_mfma_f32_16x16x32_bf16 v[92:95], a[236:239], v[52:55], v[92:95]
    ds_read_b64_tr_b16 v[70:71], v25 offset:45568
    v_exp_f32 v241, v241 clamp
    v_max_f32 v72, v178, v72
    v_max_f32 v73, v178, v73
    v_mfma_f32_16x16x32_bf16 v[96:99], a[240:243], v[48:51], v[96:99]
    v_exp_f32 v242, v242 clamp
    v_exp_f32 v243, v243 clamp
    v_max_f32_e64 v74, v178, v74
    v_mfma_f32_16x16x32_bf16 v[96:99], a[244:247], v[52:55], v[96:99]
    v_max_f32 v75, v178, v75
    v_add_f32 v240, v72, v240
    v_add_f32 v241, v73, v241
    v_add_f32 v242, v74, v242
    v_add_f32_e64 v243, v75, v243
    v_mfma_f32_16x16x32_bf16 v[100:103], a[248:251], v[48:51], v[100:103]
    buffer_load_dwordx4 v187, s[8:11], s80 offen offset:3072 lds
    v_cvt_pk_bf16_f32 v72, v240, v241
    v_cvt_pk_bf16_f32 v73, v242, v243
    v_fma_f32 v240, v76, v176, v177
    v_fma_f32 v241, v77, v176, v177
    v_mfma_f32_16x16x32_bf16 v[100:103], a[252:255], v[52:55], v[100:103]
    v_fma_f32 v242, v78, v176, v177
    v_fma_f32 v243, v79, v176, v177
    v_exp_f32 v240, v240 clamp
    s_waitcnt lgkmcnt(4)
    v_mfma_f32_16x16x32_bf16 v[104:107], a[224:227], v[56:59], v[104:107]
    s_waitcnt vmcnt(8)
    s_waitcnt lgkmcnt(0)
    s_barrier
    ds_read_b64_tr_b16 v[40:41], v30 offset:0
    v_mfma_f32_16x16x32_bf16 v[104:107], a[228:231], v[60:63], v[104:107]
    ds_read_b64_tr_b16 v[42:43], v30 offset:512
    s_lshl1_add_u32 m0, s83, 98304
    s_mov_b32 s80, 0
    buffer_load_dwordx4 v188, s[20:23], s80 offen lds
    v_mfma_f32_16x16x32_bf16 v[108:111], a[232:235], v[56:59], v[108:111]
    ds_read_b64_tr_b16 v[44:45], v30 offset:4096
    v_exp_f32 v241, v241 clamp
    v_max_f32 v76, v178, v76
    v_max_f32_e64 v77, v178, v77
    v_mfma_f32_16x16x32_bf16 v[108:111], a[236:239], v[60:63], v[108:111]
    ds_read_b64_tr_b16 v[46:47], v30 offset:4608
    v_exp_f32 v242, v242 clamp
    v_exp_f32 v243, v243 clamp
    v_mfma_f32_16x16x32_bf16 v[112:115], a[240:243], v[56:59], v[112:115]
    buffer_load_dwordx4 v189, s[20:23], s80 offen offset:1024 lds
    v_max_f32 v78, v178, v78
    v_max_f32 v79, v178, v79
    v_add_f32 v240, v76, v240
    v_add_f32 v241, v77, v241
    v_mfma_f32_16x16x32_bf16 v[112:115], a[244:247], v[60:63], v[112:115]
    v_add_f32 v242, v78, v242
    v_add_f32 v243, v79, v243
    v_cvt_pk_bf16_f32 v74, v240, v241
    v_cvt_pk_bf16_f32 v75, v242, v243
    v_fma_f32 v240, v80, v176, v177
    v_mfma_f32_16x16x32_bf16 v[116:119], a[248:251], v[56:59], v[116:119]
    buffer_load_dwordx4 v190, s[20:23], s80 offen offset:2048 lds
    v_fma_f32 v241, v81, v176, v177
    v_fma_f32 v242, v82, v176, v177
    v_fma_f32 v243, v83, v176, v177
    v_mfma_f32_16x16x32_bf16 v[116:119], a[252:255], v[60:63], v[116:119]
    v_exp_f32 v240, v240 clamp
    v_exp_f32 v241, v241 clamp
    v_max_f32_e64 v80, v178, v80
    v_mfma_f32_16x16x32_bf16 v[120:123], a[224:227], v[64:67], v[120:123]
    ds_read_b64_tr_b16 v[48:49], v31 offset:0
    v_max_f32_e64 v81, v178, v81
    v_exp_f32 v242, v242 clamp
    v_mfma_f32_16x16x32_bf16 v[120:123], a[228:231], v[68:71], v[120:123]
    ds_read_b64_tr_b16 v[50:51], v31 offset:512
    buffer_load_dwordx4 v191, s[20:23], s80 offen offset:3072 lds
    v_exp_f32 v243, v243 clamp
    v_max_f32_e64 v82, v178, v82
    v_mfma_f32_16x16x32_bf16 v[124:127], a[232:235], v[64:67], v[124:127]
    ds_read_b64_tr_b16 v[52:53], v31 offset:4096
    s_add_u32 m0, m0, 4096
    v_max_f32 v83, v178, v83
    v_add_f32 v240, v80, v240
    v_add_f32_e64 v241, v81, v241
    v_mfma_f32_16x16x32_bf16 v[124:127], a[236:239], v[68:71], v[124:127]
    ds_read_b64_tr_b16 v[54:55], v31 offset:4608
    s_mov_b32 s80, 32768
    buffer_load_dwordx4 v188, s[20:23], s80 offen lds
    v_add_f32 v242, v82, v242
    v_add_f32 v243, v83, v243
    v_mfma_f32_16x16x32_bf16 v[128:131], a[240:243], v[64:67], v[128:131]
    v_cvt_pk_bf16_f32 v76, v240, v241
    v_cvt_pk_bf16_f32 v77, v242, v243
    v_fma_f32 v240, v84, v176, v177
    v_fma_f32 v241, v85, v176, v177
    v_fma_f32 v242, v86, v176, v177
    v_mfma_f32_16x16x32_bf16 v[128:131], a[244:247], v[68:71], v[128:131]
    buffer_load_dwordx4 v189, s[20:23], s80 offen offset:1024 lds
    v_fma_f32 v243, v87, v176, v177
    v_exp_f32 v240, v240 clamp
    v_mfma_f32_16x16x32_bf16 v[132:135], a[248:251], v[64:67], v[132:135]
    v_exp_f32 v241, v241 clamp
    v_max_f32 v84, v178, v84
    v_max_f32 v85, v178, v85
    v_mfma_f32_16x16x32_bf16 v[132:135], a[252:255], v[68:71], v[132:135]
    v_exp_f32 v242, v242 clamp
    v_exp_f32 v243, v243 clamp
    v_max_f32 v86, v178, v86
    s_waitcnt lgkmcnt(4)
    v_mfma_f32_16x16x32_bf16 v[144:147], v[40:43], a[0:3], v[140:143]
    ds_read_b64_tr_b16 v[56:57], v30 offset:8192
    v_max_f32 v87, v178, v87
    v_add_f32 v240, v84, v240
    v_add_f32 v241, v85, v241
    v_add_f32 v242, v86, v242
    v_mfma_f32_16x16x32_bf16 v[144:147], v[44:47], a[4:7], v[144:147]
    ds_read_b64_tr_b16 v[58:59], v30 offset:8704
    buffer_load_dwordx4 v190, s[20:23], s80 offen offset:2048 lds
    v_add_f32_e64 v243, v87, v243
    v_cvt_pk_bf16_f32 v78, v240, v241
    v_cvt_pk_bf16_f32 v79, v242, v243
    v_mfma_f32_16x16x32_bf16 v[148:151], v[40:43], a[8:11], v[140:143]
    ds_read_b64_tr_b16 v[60:61], v30 offset:12288
    v_readfirstlane_b32 s56, v34
    s_mov_b32 s86, 0
    s_cmp_ge_u32 s56, 32
    s_cbranch_scc0 L_lslowA
L_lokA:
    v_mfma_f32_16x16x32_bf16 v[148:151], v[44:47], a[12:15], v[148:151]
    ds_read_b64_tr_b16 v[62:63], v30 offset:12800
    buffer_load_dwordx4 v191, s[20:23], s80 offen offset:3072 lds
    v_fma_f32 v240, v88, v176, v177
    v_fma_f32 v241, v89, v176, v177
    v_mfma_f32_16x16x32_bf16 v[200:203], v[72:75], v[180:183], 0
    v_fma_f32 v242, v90, v176, v177
    v_fma_f32 v243, v91, v176, v177
    v_exp_f32 v240, v240 clamp
    v_mfma_f32_16x16x32_bf16 v[152:155], v[40:43], a[16:19], v[140:143]
    s_lshl1_add_u32 m0, s83, 131072
    s_mov_b32 s80, 262144
    v_exp_f32 v241, v241 clamp
    v_mfma_f32_16x16x32_bf16 v[200:203], v[76:79], v[180:183], v[200:203]
    buffer_load_dwordx4 v188, s[20:23], s80 offen lds
    v_max_f32 v88, v178, v88
    v_max_f32 v89, v178, v89
    v_exp_f32 v242, v242 clamp
    v_mfma_f32_16x16x32_bf16 v[152:155], v[44:47], a[20:23], v[152:155]
    v_exp_f32 v243, v243 clamp
    v_max_f32 v90, v178, v90
    v_max_f32 v91, v178, v91
    v_add_f32_e64 v240, v88, v240
    v_mfma_f32_16x16x32_bf16 v[156:159], v[40:43], a[24:27], v[140:143]
    buffer_load_dwordx4 v189, s[20:23], s80 offen offset:1024 lds
    v_add_f32 v241, v89, v241
    v_add_f32 v242, v90, v242
    v_add_f32_e64 v243, v91, v243
    v_cvt_pk_bf16_f32 v88, v240, v241
    v_mfma_f32_16x16x32_bf16 v[156:159], v[44:47], a[28:31], v[156:159]
    v_cvt_pk_bf16_f32 v89, v242, v243
    v_fma_f32 v240, v92, v176, v177
    v_fma_f32 v241, v93, v176, v177
    v_fma_f32 v242, v94, v176, v177
    v_fma_f32 v243, v95, v176, v177
    s_waitcnt lgkmcnt(4)
    s_nop 0
    v_mfma_f32_16x16x32_bf16 v[160:163], v[48:51], a[0:3], v[140:143]
    ds_read_b64_tr_b16 v[64:65], v31 offset:8192
    buffer_load_dwordx4 v190, s[20:23], s80 offen offset:2048 lds
    v_exp_f32 v240, v240 clamp
    v_mfma_f32_16x16x32_bf16 v[160:163], v[52:55], a[4:7], v[160:163]
    ds_read_b64_tr_b16 v[66:67], v31 offset:8704
    v_exp_f32 v241, v241 clamp
    v_max_f32 v92, v178, v92
    v_max_f32 v93, v178, v93
    v_mfma_f32_16x16x32_bf16 v[164:167], v[48:51], a[8:11], v[140:143]
    ds_read_b64_tr_b16 v[68:69], v31 offset:12288
    buffer_load_dwordx4 v191, s[20:23], s80 offen offset:3072 lds
    v_exp_f32 v242, v242 clamp
    v_mfma_f32_16x16x32_bf16 v[164:167], v[52:55], a[12:15], v[164:167]
    ds_read_b64_tr_b16 v[70:71], v31 offset:12800
    s_add_u32 m0, m0, 4096
    v_exp_f32 v243, v243 clamp
    v_max_f32_e64 v94, v178, v94
    v_mfma_f32_16x16x32_bf16 v[168:171], v[48:51], a[16:19], v[140:143]
    s_mov_b32 s80, 294912
    v_max_f32 v95, v178, v95
    v_add_f32 v240, v92, v240
    v_add_f32 v241, v93, v241
    v_add_f32 v242, v94, v242
    v_mfma_f32_16x16x32_bf16 v[168:171], v[52:55], a[20:23], v[168:171]
    buffer_load_dwordx4 v188, s[20:23], s80 offen lds
    v_add_f32_e64 v243, v95, v243
    v_cvt_pk_bf16_f32 v90, v240, v241
    v_cvt_pk_bf16_f32 v91, v242, v243
    v_cvt_pk_bf16_f32 v104, v104, v105
    v_mfma_f32_16x16x32_bf16 v[172:175], v[48:51], a[24:27], v[140:143]
    v_cvt_pk_bf16_f32 v105, v106, v107
    v_mfma_f32_16x16x32_bf16 v[204:207], v[88:91], v[180:183], 0
    v_cvt_pk_bf16_f32 v106, v108, v109
    v_cvt_pk_bf16_f32 v107, v110, v111
    v_cvt_pk_bf16_f32 v108, v112, v113
    v_cvt_pk_bf16_f32 v109, v114, v115
    v_cvt_pk_bf16_f32 v110, v116, v117
    v_mfma_f32_16x16x32_bf16 v[172:175], v[52:55], a[28:31], v[172:175]
    buffer_load_dwordx4 v189, s[20:23], s80 offen offset:1024 lds
    v_cvt_pk_bf16_f32 v111, v118, v119
    v_cvt_pk_bf16_f32 v120, v120, v121
    v_cvt_pk_bf16_f32 v121, v122, v123
    v_mfma_f32_16x16x32_bf16 v[192:195], v[72:75], v[104:107], 0
    v_cvt_pk_bf16_f32 v122, v124, v125
    v_cvt_pk_bf16_f32 v123, v126, v127
    v_cvt_pk_bf16_f32 v124, v128, v129
    v_cvt_pk_bf16_f32 v125, v130, v131
    v_cvt_pk_bf16_f32 v126, v132, v133
    s_waitcnt lgkmcnt(4)
    s_nop 0
    v_mfma_f32_16x16x32_bf16 v[144:147], v[56:59], a[32:35], v[144:147]
    ds_read_b64_tr_b16 v[40:41], v30 offset:16384
    v_cvt_pk_bf16_f32 v127, v134, v135
    v_fma_f32 v240, v96, v176, v177
    v_fma_f32 v241, v97, v176, v177
    v_mfma_f32_16x16x32_bf16 v[192:195], v[76:79], v[108:111], v[192:195]
    buffer_load_dwordx4 v190, s[20:23], s80 offen offset:2048 lds
    v_fma_f32 v242, v98, v176, v177
    v_fma_f32 v243, v99, v176, v177
    v_exp_f32 v240, v240 clamp
    v_mfma_f32_16x16x32_bf16 v[144:147], v[60:63], a[36:39], v[144:147]
    ds_read_b64_tr_b16 v[42:43], v30 offset:16896
    v_exp_f32 v241, v241 clamp
    v_max_f32 v96, v178, v96
    v_max_f32 v97, v178, v97
    v_mfma_f32_16x16x32_bf16 v[196:199], v[88:91], v[120:123], 0
    buffer_load_dwordx4 v191, s[20:23], s80 offen offset:3072 lds
    v_exp_f32 v242, v242 clamp
    v_exp_f32 v243, v243 clamp
    v_mfma_f32_16x16x32_bf16 v[148:151], v[56:59], a[40:43], v[148:151]
    ds_read_b64_tr_b16 v[44:45], v30 offset:20480
    v_max_f32 v98, v178, v98
    v_max_f32 v99, v178, v99
    v_add_f32 v240, v96, v240
    v_add_f32 v241, v97, v241
    v_mfma_f32_16x16x32_bf16 v[148:151], v[60:63], a[44:47], v[148:151]
    ds_read_b64_tr_b16 v[46:47], v30 offset:20992
    v_add_f32 v242, v98, v242
    v_add_f32 v243, v99, v243
    v_cvt_pk_bf16_f32 v92, v240, v241
    v_cvt_pk_bf16_f32 v93, v242, v243
    v_mfma_f32_16x16x32_bf16 v[152:155], v[56:59], a[48:51], v[152:155]
    v_fma_f32 v240, v100, v176, v177
    v_fma_f32 v241, v101, v176, v177
    v_fma_f32 v242, v102, v176, v177
    v_fma_f32 v243, v103, v176, v177
    v_mfma_f32_16x16x32_bf16 v[152:155], v[60:63], a[52:55], v[152:155]
    v_exp_f32 v240, v240 clamp
    v_exp_f32 v241, v241 clamp
    v_max_f32_e64 v100, v178, v100
    v_mfma_f32_16x16x32_bf16 v[156:159], v[56:59], a[56:59], v[156:159]
    v_max_f32_e64 v101, v178, v101
    v_exp_f32 v242, v242 clamp
    v_exp_f32 v243, v243 clamp
    v_mfma_f32_16x16x32_bf16 v[156:159], v[60:63], a[60:63], v[156:159]
    v_max_f32 v102, v178, v102
    v_max_f32 v103, v178, v103
    v_add_f32 v240, v100, v240
    v_add_f32 v241, v101, v241
    v_add_f32 v242, v102, v242
    s_waitcnt lgkmcnt(4)
    v_mfma_f32_16x16x32_bf16 v[160:163], v[64:67], a[32:35], v[160:163]
    ds_read_b64_tr_b16 v[48:49], v31 offset:16384
    v_add_f32_e64 v243, v103, v243
    v_cvt_pk_bf16_f32 v94, v240, v241
    v_cvt_pk_bf16_f32 v95, v242, v243
    v_mfma_f32_16x16x32_bf16 v[160:163], v[68:71], a[36:39], v[160:163]
    ds_read_b64_tr_b16 v[50:51], v31 offset:16896
    v_mfma_f32_16x16x32_bf16 v[164:167], v[64:67], a[40:43], v[164:167]
    s_cmp_eq_u32 s72, 0
    v_mfma_f32_16x16x32_bf16 v[196:199], v[92:95], v[124:127], v[196:199]
    v_mfma_f32_16x16x32_bf16 v[204:207], v[92:95], v[180:183], v[204:207]
    v_mfma_f32_16x16x32_bf16 v[164:167], v[68:71], a[44:47], v[164:167]
    v_mfma_f32_16x16x32_bf16 v[168:171], v[64:67], a[48:51], v[168:171]
    s_nop 3
    s_cbranch_scc1 L_x0
    s_nop 0
    ds_write_b128 v38, v[192:195]
    ds_write_b128 v38, v[196:199] offset:1024
    v_mfma_f32_16x16x32_bf16 v[168:171], v[68:71], a[52:55], v[168:171]
    v_mfma_f32_16x16x32_bf16 v[172:175], v[64:67], a[56:59], v[172:175]
    v_mfma_f32_16x16x32_bf16 v[172:175], v[68:71], a[60:63], v[172:175]
    s_waitcnt lgkmcnt(0)
    s_barrier
    ds_read_b128 v[208:211], v39
    ds_read_b128 v[212:215], v39 offset:1024
    v_mfma_f32_16x16x32_bf16 v[144:147], v[40:43], a[64:67], v[144:147]
    v_mfma_f32_16x16x32_bf16 v[144:147], v[44:47], a[68:71], v[144:147]
    s_waitcnt lgkmcnt(1)
    v_add_f32 v208, v208, v200
    v_add_f32 v209, v209, v201
    v_add_f32 v210, v210, v202
    v_add_f32 v211, v211, v203
    s_waitcnt lgkmcnt(0)
    v_add_f32 v212, v212, v204
    v_add_f32 v213, v213, v205
    v_add_f32 v214, v214, v206
    v_add_f32_e64 v215, v215, v207
    s_branch L_x1
L_x0:
    ds_write_b128 v38, v[200:203]
    ds_write_b128 v38, v[204:207] offset:1024
    v_mfma_f32_16x16x32_bf16 v[168:171], v[68:71], a[52:55], v[168:171]
    v_mfma_f32_16x16x32_bf16 v[172:175], v[64:67], a[56:59], v[172:175]
    v_mfma_f32_16x16x32_bf16 v[172:175], v[68:71], a[60:63], v[172:175]
    s_waitcnt lgkmcnt(0)
    s_barrier
    ds_read_b128 v[208:211], v39
    ds_read_b128 v[212:215], v39 offset:1024
    v_mfma_f32_16x16x32_bf16 v[144:147], v[40:43], a[64:67], v[144:147]
    v_mfma_f32_16x16x32_bf16 v[144:147], v[44:47], a[68:71], v[144:147]
    s_waitcnt lgkmcnt(1)
    v_add_f32 v208, v208, v192
    v_add_f32 v209, v209, v193
    v_add_f32 v210, v210, v194
    v_add_f32 v211, v211, v195
    s_waitcnt lgkmcnt(0)
    v_add_f32 v212, v212, v196
    v_add_f32 v213, v213, v197
    v_add_f32 v214, v214, v198
    v_add_f32 v215, v215, v199
L_x1:
    v_cvt_pk_bf16_f32 v208, v208, v209
    v_cvt_pk_bf16_f32 v209, v210, v211
    v_cvt_pk_bf16_f32 v210, v212, v213
    v_cvt_pk_bf16_f32 v211, v214, v215
    v_min_u32 v208, -2, v208
    v_min_u32 v209, -2, v209
    v_min_u32 v210, -2, v210
    v_min_u32 v211, -2, v211
    buffer_store_dwordx4 v[208:211], v35, s[12:15], s85 offen sc1
    v_mfma_f32_16x16x32_bf16 v[148:151], v[40:43], a[72:75], v[148:151]
    ds_read_b64_tr_b16 v[52:53], v31 offset:20480
    ds_read_b64_tr_b16 v[54:55], v31 offset:20992
    v_mfma_f32_16x16x32_bf16 v[148:151], v[44:47], a[76:79], v[148:151]
    ds_read_b64_tr_b16 v[56:57], v30 offset:24576
    s_add_u32 s74, s85, 4096
    v_mfma_f32_16x16x32_bf16 v[152:155], v[40:43], a[80:83], v[152:155]
    ds_read_b64_tr_b16 v[58:59], v30 offset:25088
    v_mfma_f32_16x16x32_bf16 v[152:155], v[44:47], a[84:87], v[152:155]
    ds_read_b64_tr_b16 v[60:61], v30 offset:28672
    ds_read_b64_tr_b16 v[62:63], v30 offset:29184
    v_mfma_f32_16x16x32_bf16 v[156:159], v[40:43], a[88:91], v[156:159]
    v_mfma_f32_16x16x32_bf16 v[156:159], v[44:47], a[92:95], v[156:159]
    v_mfma_f32_16x16x32_bf16 v[160:163], v[48:51], a[64:67], v[160:163]
    ds_read_b64_tr_b16 v[64:65], v31 offset:24576
    s_waitcnt lgkmcnt(5)
    s_nop 0
    v_mfma_f32_16x16x32_bf16 v[160:163], v[52:55], a[68:71], v[160:163]
    ds_read_b64_tr_b16 v[66:67], v31 offset:25088
    v_mfma_f32_16x16x32_bf16 v[164:167], v[48:51], a[72:75], v[164:167]
    ds_read_b64_tr_b16 v[68:69], v31 offset:28672
    v_mfma_f32_16x16x32_bf16 v[164:167], v[52:55], a[76:79], v[164:167]
    ds_read_b64_tr_b16 v[70:71], v31 offset:29184
    v_mfma_f32_16x16x32_bf16 v[168:171], v[48:51], a[80:83], v[168:171]
    v_mfma_f32_16x16x32_bf16 v[168:171], v[52:55], a[84:87], v[168:171]
    v_mfma_f32_16x16x32_bf16 v[172:175], v[48:51], a[88:91], v[172:175]
    v_mfma_f32_16x16x32_bf16 v[172:175], v[52:55], a[92:95], v[172:175]
    s_waitcnt lgkmcnt(4)
    v_mfma_f32_16x16x32_bf16 v[144:147], v[56:59], a[96:99], v[144:147]
    s_waitcnt vmcnt(17)
    s_waitcnt lgkmcnt(0)
    s_barrier
    ds_read_b64_tr_b16 v[40:41], v30 offset:32768
    s_lshl1_add_u32 m0, s83, 32768
    s_xor_b32 s80, s72, s42
    s_xor_b32 s80, s80, 2
    s_lshl_b32 s80, s80, 7
    s_nop 0
    buffer_load_dwordx4 v248, s[24:27], s80 offen lds
    v_mfma_f32_16x16x32_bf16 v[144:147], v[60:63], a[100:103], v[144:147]
    ds_read_b64_tr_b16 v[42:43], v30 offset:33280
    v_mfma_f32_16x16x32_bf16 v[148:151], v[56:59], a[104:107], v[148:151]
    ds_read_b64_tr_b16 v[44:45], v30 offset:36864
    buffer_load_dwordx4 v249, s[24:27], s80 offen offset:1024 lds
    v_mfma_f32_16x16x32_bf16 v[148:151], v[60:63], a[108:111], v[148:151]
    ds_read_b64_tr_b16 v[46:47], v30 offset:37376
    v_mfma_f32_16x16x32_bf16 v[152:155], v[56:59], a[112:115], v[152:155]
    v_mfma_f32_16x16x32_bf16 v[152:155], v[60:63], a[116:119], v[152:155]
    v_mfma_f32_16x16x32_bf16 v[156:159], v[56:59], a[120:123], v[156:159]
    buffer_load_dwordx4 v250, s[24:27], s80 offen offset:2048 lds
    v_mfma_f32_16x16x32_bf16 v[156:159], v[60:63], a[124:127], v[156:159]
    v_mfma_f32_16x16x32_bf16 v[160:163], v[64:67], a[96:99], v[160:163]
    ds_read_b64_tr_b16 v[48:49], v31 offset:32768
    v_mfma_f32_16x16x32_bf16 v[160:163], v[68:71], a[100:103], v[160:163]
    ds_read_b64_tr_b16 v[50:51], v31 offset:33280
    v_mfma_f32_16x16x32_bf16 v[164:167], v[64:67], a[104:107], v[164:167]
    ds_read_b64_tr_b16 v[52:53], v31 offset:36864
    buffer_load_dwordx4 v251, s[24:27], s80 offen offset:3072 lds
    v_mfma_f32_16x16x32_bf16 v[164:167], v[68:71], a[108:111], v[164:167]
    ds_read_b64_tr_b16 v[54:55], v31 offset:37376
    s_add_u32 m0, m0, 4096
    v_mfma_f32_16x16x32_bf16 v[168:171], v[64:67], a[112:115], v[168:171]
    s_waitcnt vmcnt(5)
    s_barrier
    ds_read_b64_tr_b16 a[0:1], v26 offset:0
    ds_read_b64_tr_b16 a[2:3], v26 offset:2048
    v_mfma_f32_16x16x32_bf16 v[168:171], v[68:71], a[116:119], v[168:171]
    ds_read_b64_tr_b16 a[4:5], v27 offset:0
    ds_read_b64_tr_b16 a[6:7], v27 offset:2048
    v_mfma_f32_16x16x32_bf16 v[172:175], v[64:67], a[120:123], v[172:175]
    ds_read_b64_tr_b16 a[8:9], v28 offset:0
    ds_read_b64_tr_b16 a[10:11], v28 offset:2048
    s_add_u32 s80, s80, 32768
    buffer_load_dwordx4 v248, s[24:27], s80 offen lds
    v_mfma_f32_16x16x32_bf16 v[172:175], v[68:71], a[124:127], v[172:175]
    ds_read_b64_tr_b16 a[12:13], v29 offset:0
    ds_read_b64_tr_b16 a[14:15], v29 offset:2048
    s_waitcnt lgkmcnt(12)
    s_nop 0
    v_mfma_f32_16x16x32_bf16 v[144:147], v[40:43], a[128:131], v[144:147]
    ds_read_b64_tr_b16 v[56:57], v30 offset:40960
    ds_read_b64_tr_b16 a[16:17], v26 offset:4096
    v_mfma_f32_16x16x32_bf16 v[144:147], v[44:47], a[132:135], v[144:147]
    ds_read_b64_tr_b16 v[58:59], v30 offset:41472
    ds_read_b64_tr_b16 a[18:19], v26 offset:6144
    v_mfma_f32_16x16x32_bf16 v[148:151], v[40:43], a[136:139], v[148:151]
    ds_read_b64_tr_b16 v[60:61], v30 offset:45056
    ds_read_b64_tr_b16 a[20:21], v27 offset:4096
    buffer_load_dwordx4 v249, s[24:27], s80 offen offset:1024 lds
    v_mfma_f32_16x16x32_bf16 v[148:151], v[44:47], a[140:143], v[148:151]
    ds_read_b64_tr_b16 v[62:63], v30 offset:45568
    ds_read_b64_tr_b16 a[22:23], v27 offset:6144
    v_mfma_f32_16x16x32_bf16 v[152:155], v[40:43], a[144:147], v[152:155]
    ds_read_b64_tr_b16 a[24:25], v28 offset:4096
    v_mfma_f32_16x16x32_bf16 v[152:155], v[44:47], a[148:151], v[152:155]
    ds_read_b64_tr_b16 a[26:27], v28 offset:6144
    v_mfma_f32_16x16x32_bf16 v[156:159], v[40:43], a[152:155], v[156:159]
    ds_read_b64_tr_b16 a[28:29], v29 offset:4096
    buffer_load_dwordx4 v250, s[24:27], s80 offen offset:2048 lds
    v_mfma_f32_16x16x32_bf16 v[156:159], v[44:47], a[156:159], v[156:159]
    ds_read_b64_tr_b16 a[30:31], v29 offset:6144
    s_waitcnt lgkmcnt(15)
    s_nop 0
    v_mfma_f32_16x16x32_bf16 v[160:163], v[48:51], a[128:131], v[160:163]
    ds_read_b64_tr_b16 v[64:65], v30 offset:49152
    ds_read_b64_tr_b16 a[32:33], v26 offset:8192
    v_mfma_f32_16x16x32_bf16 v[160:163], v[52:55], a[132:135], v[160:163]
    ds_read_b64_tr_b16 v[66:67], v30 offset:49664
    ds_read_b64_tr_b16 a[34:35], v26 offset:10240
    v_mfma_f32_16x16x32_bf16 v[164:167], v[48:51], a[136:139], v[164:167]
    ds_read_b64_tr_b16 v[68:69], v30 offset:53248
    ds_read_b64_tr_b16 a[36:37], v27 offset:8192
    buffer_load_dwordx4 v251, s[24:27], s80 offen offset:3072 lds
    v_mfma_f32_16x16x32_bf16 v[164:167], v[52:55], a[140:143], v[164:167]
    ds_read_b64_tr_b16 v[70:71], v30 offset:53760
    ds_read_b64_tr_b16 a[38:39], v27 offset:10240
    v_mfma_f32_16x16x32_bf16 v[168:171], v[48:51], a[144:147], v[168:171]
    ds_read_b64_tr_b16 a[40:41], v28 offset:8192
    s_lshl1_add_u32 m0, s83, 4096
    v_mfma_f32_16x16x32_bf16 v[168:171], v[52:55], a[148:151], v[168:171]
    ds_read_b64_tr_b16 a[42:43], v28 offset:10240
    s_lshl_b32 s80, s52, 7
    s_nop 0
    v_mfma_f32_16x16x32_bf16 v[172:175], v[48:51], a[152:155], v[172:175]
    ds_read_b64_tr_b16 a[44:45], v29 offset:8192
    buffer_load_dwordx4 v138, s[4:7], s80 offen lds
    v_mfma_f32_16x16x32_bf16 v[172:175], v[52:55], a[156:159], v[172:175]
    ds_read_b64_tr_b16 a[46:47], v29 offset:10240
    s_add_u32 s80, s80, 64512
    s_waitcnt lgkmcnt(14)
    s_nop 0
    v_mfma_f32_16x16x32_bf16 v[144:147], v[56:59], a[160:163], v[144:147]
    ds_read_b64_tr_b16 v[40:41], v30 offset:57344
    ds_read_b64_tr_b16 a[48:49], v26 offset:12288
    v_mfma_f32_16x16x32_bf16 v[144:147], v[60:63], a[164:167], v[144:147]
    ds_read_b64_tr_b16 v[42:43], v30 offset:57856
    ds_read_b64_tr_b16 a[50:51], v26 offset:14336
    v_mfma_f32_16x16x32_bf16 v[148:151], v[56:59], a[168:171], v[148:151]
    ds_read_b64_tr_b16 v[44:45], v30 offset:61440
    ds_read_b64_tr_b16 a[52:53], v27 offset:12288
    buffer_load_dwordx4 v138, s[4:7], s80 offen offset:1024 lds
    v_mfma_f32_16x16x32_bf16 v[148:151], v[60:63], a[172:175], v[148:151]
    ds_read_b64_tr_b16 v[46:47], v30 offset:61952
    ds_read_b64_tr_b16 a[54:55], v27 offset:14336
    v_mfma_f32_16x16x32_bf16 v[152:155], v[56:59], a[176:179], v[152:155]
    ds_read_b64_tr_b16 a[56:57], v28 offset:12288
    s_lshl1_add_u32 m0, s83, 6144
    v_mfma_f32_16x16x32_bf16 v[152:155], v[60:63], a[180:183], v[152:155]
    ds_read_b64_tr_b16 a[58:59], v28 offset:14336
    s_lshl_b32 s80, s76, 7
    s_nop 0
    v_mfma_f32_16x16x32_bf16 v[156:159], v[56:59], a[184:187], v[156:159]
    ds_read_b64_tr_b16 a[60:61], v29 offset:12288
    buffer_load_dword v139, s[28:31], s80 offen lds
    v_mfma_f32_16x16x32_bf16 v[156:159], v[60:63], a[188:191], v[156:159]
    ds_read_b64_tr_b16 a[62:63], v29 offset:14336
    s_waitcnt lgkmcnt(14)
    s_nop 0
    v_mfma_f32_16x16x32_bf16 v[144:147], v[64:67], a[192:195], v[144:147]
    ds_read_b64_tr_b16 v[48:49], v31 offset:40960
    ds_read_b64_tr_b16 a[64:65], v26 offset:16384
    v_mfma_f32_16x16x32_bf16 v[144:147], v[68:71], a[196:199], v[144:147]
    ds_read_b64_tr_b16 v[50:51], v31 offset:41472
    ds_read_b64_tr_b16 a[66:67], v26 offset:18432
    v_mfma_f32_16x16x32_bf16 v[148:151], v[64:67], a[200:203], v[148:151]
    ds_read_b64_tr_b16 v[52:53], v31 offset:45056
    ds_read_b64_tr_b16 a[68:69], v27 offset:16384
    v_mfma_f32_16x16x32_bf16 v[148:151], v[68:71], a[204:207], v[148:151]
    ds_read_b64_tr_b16 v[54:55], v31 offset:45568
    ds_read_b64_tr_b16 a[70:71], v27 offset:18432
    v_mfma_f32_16x16x32_bf16 v[152:155], v[64:67], a[208:211], v[152:155]
    ds_read_b64_tr_b16 a[72:73], v28 offset:16384
    v_mfma_f32_16x16x32_bf16 v[152:155], v[68:71], a[212:215], v[152:155]
    ds_read_b64_tr_b16 a[74:75], v28 offset:18432
    v_mfma_f32_16x16x32_bf16 v[156:159], v[64:67], a[216:219], v[156:159]
    ds_read_b64_tr_b16 a[76:77], v29 offset:16384
    v_mfma_f32_16x16x32_bf16 v[156:159], v[68:71], a[220:223], v[156:159]
    ds_read_b64_tr_b16 a[78:79], v29 offset:18432
    s_waitcnt lgkmcnt(14)
    s_nop 0
    v_mfma_f32_16x16x32_bf16 v[144:147], v[40:43], a[224:227], v[144:147]
    ds_read_b64_tr_b16 v[56:57], v31 offset:49152
    ds_read_b64_tr_b16 a[80:81], v26 offset:20480
    v_mfma_f32_16x16x32_bf16 v[144:147], v[44:47], a[228:231], v[144:147]
    ds_read_b64_tr_b16 v[58:59], v31 offset:49664
    ds_read_b64_tr_b16 a[82:83], v26 offset:22528
    v_mfma_f32_16x16x32_bf16 v[148:151], v[40:43], a[232:235], v[148:151]
    ds_read_b64_tr_b16 v[60:61], v31 offset:53248
    ds_read_b64_tr_b16 a[84:85], v27 offset:20480
    v_mfma_f32_16x16x32_bf16 v[148:151], v[44:47], a[236:239], v[148:151]
    ds_read_b64_tr_b16 v[62:63], v31 offset:53760
    ds_read_b64_tr_b16 a[86:87], v27 offset:22528
    v_mfma_f32_16x16x32_bf16 v[152:155], v[40:43], a[240:243], v[152:155]
    ds_read_b64_tr_b16 a[88:89], v28 offset:20480
    v_mfma_f32_16x16x32_bf16 v[152:155], v[44:47], a[244:247], v[152:155]
    ds_read_b64_tr_b16 a[90:91], v28 offset:22528
    v_mfma_f32_16x16x32_bf16 v[156:159], v[40:43], a[248:251], v[156:159]
    ds_read_b64_tr_b16 a[92:93], v29 offset:20480
    v_mfma_f32_16x16x32_bf16 v[156:159], v[44:47], a[252:255], v[156:159]
    ds_read_b64_tr_b16 a[94:95], v29 offset:22528
    s_waitcnt lgkmcnt(14)
    v_mfma_f32_16x16x32_bf16 v[160:163], v[48:51], a[160:163], v[160:163]
    ds_read_b64_tr_b16 v[64:65], v31 offset:57344
    ds_read_b64_tr_b16 a[96:97], v26 offset:24576
    s_mov_b32 s92, m0
    s_lshl1_add_u32 m0, s83, 2048
    s_nop 0
    buffer_load_dwordx4 v36, s[12:15], s85 offen sc1 lds
    s_mov_b32 m0, s92
    v_mfma_f32_16x16x32_bf16 v[160:163], v[52:55], a[164:167], v[160:163]
    ds_read_b64_tr_b16 v[66:67], v31 offset:57856
    ds_read_b64_tr_b16 a[98:99], v26 offset:26624
    v_mfma_f32_16x16x32_bf16 v[164:167], v[48:51], a[168:171], v[164:167]
    ds_read_b64_tr_b16 v[68:69], v31 offset:61440
    ds_read_b64_tr_b16 a[100:101], v27 offset:24576
    buffer_load_dwordx4 v[72:75], v37, s[12:15], s85 offen offset:0 sc1
    v_mfma_f32_16x16x32_bf16 v[164:167], v[52:55], a[172:175], v[164:167]
    ds_read_b64_tr_b16 v[70:71], v31 offset:61952
    ds_read_b64_tr_b16 a[102:103], v27 offset:26624
    v_mfma_f32_16x16x32_bf16 v[168:171], v[48:51], a[176:179], v[168:171]
    ds_read_b64_tr_b16 a[104:105], v28 offset:24576
    buffer_load_dwordx4 v[76:79], v37, s[12:15], s85 offen offset:1024 sc1
    v_mfma_f32_16x16x32_bf16 v[168:171], v[52:55], a[180:183], v[168:171]
    ds_read_b64_tr_b16 a[106:107], v28 offset:26624
    v_fma_f32 v240, v144, v176, v177
    v_mfma_f32_16x16x32_bf16 v[172:175], v[48:51], a[184:187], v[172:175]
    ds_read_b64_tr_b16 a[108:109], v29 offset:24576
    buffer_load_dwordx4 v[80:83], v37, s[12:15], s85 offen offset:2048 sc1
    v_mfma_f32_16x16x32_bf16 v[172:175], v[52:55], a[188:191], v[172:175]
    ds_read_b64_tr_b16 a[110:111], v29 offset:26624
    v_fma_f32 v241, v145, v176, v177
    s_waitcnt lgkmcnt(14)
    s_nop 0
    v_mfma_f32_16x16x32_bf16 v[160:163], v[56:59], a[192:195], v[160:163]
    ds_read_b64_tr_b16 a[112:113], v26 offset:28672
    buffer_load_dwordx4 v[84:87], v37, s[12:15], s85 offen offset:3072 sc1
    v_mfma_f32_16x16x32_bf16 v[160:163], v[60:63], a[196:199], v[160:163]
    ds_read_b64_tr_b16 a[114:115], v26 offset:30720
    v_fma_f32 v242, v146, v176, v177
    v_mfma_f32_16x16x32_bf16 v[164:167], v[56:59], a[200:203], v[164:167]
    ds_read_b64_tr_b16 a[116:117], v27 offset:28672
    buffer_load_dwordx4 v[88:91], v37, s[12:15], s74 offen offset:0 sc1
    v_mfma_f32_16x16x32_bf16 v[164:167], v[60:63], a[204:207], v[164:167]
    ds_read_b64_tr_b16 a[118:119], v27 offset:30720
    v_fma_f32 v243, v147, v176, v177
    v_mfma_f32_16x16x32_bf16 v[168:171], v[56:59], a[208:211], v[168:171]
    ds_read_b64_tr_b16 a[120:121], v28 offset:28672
    buffer_load_dwordx4 v[92:95], v37, s[12:15], s74 offen offset:1024 sc1
    v_mfma_f32_16x16x32_bf16 v[168:171], v[60:63], a[212:215], v[168:171]
    ds_read_b64_tr_b16 a[122:123], v28 offset:30720
    v_mfma_f32_16x16x32_bf16 v[172:175], v[56:59], a[216:219], v[172:175]
    ds_read_b64_tr_b16 a[124:125], v29 offset:28672
    buffer_load_dwordx4 v[96:99], v37, s[12:15], s74 offen offset:2048 sc1
    v_mfma_f32_16x16x32_bf16 v[172:175], v[60:63], a[220:223], v[172:175]
    ds_read_b64_tr_b16 a[126:127], v29 offset:30720
    s_waitcnt lgkmcnt(10)
    s_nop 0
    v_mfma_f32_16x16x32_bf16 v[160:163], v[64:67], a[224:227], v[160:163]
    buffer_load_dwordx4 v[100:103], v37, s[12:15], s74 offen offset:3072 sc1
    v_mfma_f32_16x16x32_bf16 v[160:163], v[68:71], a[228:231], v[160:163]
    v_exp_f32 v240, v240 clamp
    v_mfma_f32_16x16x32_bf16 v[164:167], v[64:67], a[232:235], v[164:167]
    v_exp_f32 v241, v241 clamp
    v_mfma_f32_16x16x32_bf16 v[164:167], v[68:71], a[236:239], v[164:167]
    v_max_f32 v144, v178, v144
    v_max_f32 v145, v178, v145
    v_mfma_f32_16x16x32_bf16 v[168:171], v[64:67], a[240:243], v[168:171]
    s_waitcnt lgkmcnt(0)
    s_barrier
    s_lshl1_add_u32 m0, s83, 98304
    s_xor_b32 s80, s72, s42
    s_xor_b32 s80, s80, 0
    s_lshl_b32 s80, s80, 7
    s_nop 0
    buffer_load_dwordx4 v248, s[24:27], s80 offen lds
    v_mfma_f32_16x16x32_bf16 v[168:171], v[68:71], a[244:247], v[168:171]
    v_exp_f32 v242, v242 clamp
    v_mfma_f32_16x16x32_bf16 v[172:175], v[64:67], a[248:251], v[172:175]
    v_exp_f32 v243, v243 clamp
    v_mfma_f32_16x16x32_bf16 v[172:175], v[68:71], a[252:255], v[172:175]
    buffer_load_dwordx4 v249, s[24:27], s80 offen offset:1024 lds
    v_max_f32 v146, v178, v146
    v_max_f32 v147, v178, v147
    v_add_f32 v240, v144, v240
    v_add_f32 v241, v145, v241
    v_add_f32 v242, v146, v242
    v_add_f32 v243, v147, v243
    v_cvt_pk_bf16_f32 v224, v240, v241
    v_cvt_pk_bf16_f32 v225, v242, v243
    v_fma_f32 v240, v148, v176, v177
    buffer_load_dwordx4 v250, s[24:27], s80 offen offset:2048 lds
    v_fma_f32 v241, v149, v176, v177
    v_fma_f32 v242, v150, v176, v177
    v_fma_f32 v243, v151, v176, v177
    v_exp_f32 v240, v240 clamp
    v_exp_f32 v241, v241 clamp
    v_max_f32 v148, v178, v148
    v_max_f32 v149, v178, v149
    v_exp_f32 v242, v242 clamp
    v_exp_f32 v243, v243 clamp
    v_max_f32 v150, v178, v150
    v_max_f32 v151, v178, v151
    v_add_f32 v240, v148, v240
    v_add_f32 v241, v149, v241
    v_add_f32_e64 v242, v150, v242
    buffer_load_dwordx4 v251, s[24:27], s80 offen offset:3072 lds
    v_add_f32_e64 v243, v151, v243
    v_cvt_pk_bf16_f32 v228, v240, v241
    v_cvt_pk_bf16_f32 v229, v242, v243
    v_fma_f32 v240, v152, v176, v177
    v_fma_f32 v241, v153, v176, v177
    v_fma_f32 v242, v154, v176, v177
    v_fma_f32 v243, v155, v176, v177
    v_exp_f32 v240, v240 clamp
    v_exp_f32 v241, v241 clamp
    v_max_f32 v152, v178, v152
    v_max_f32 v153, v178, v153
    v_exp_f32 v242, v242 clamp
    v_exp_f32 v243, v243 clamp
    v_max_f32_e64 v154, v178, v154
    s_add_u32 m0, m0, 4096
    s_add_u32 s80, s80, 32768
    buffer_load_dwordx4 v248, s[24:27], s80 offen lds
    v_max_f32 v155, v178, v155
    v_add_f32 v240, v152, v240
    v_add_f32 v241, v153, v241
    v_add_f32 v242, v154, v242
    v_add_f32_e64 v243, v155, v243
    v_cvt_pk_bf16_f32 v232, v240, v241
    v_cvt_pk_bf16_f32 v233, v242, v243
    s_waitcnt vmcnt(12)
    s_nop 0
    v_mfma_f32_16x16x16_bf16 v[192:195], v[136:137], v[72:73], 0
    ds_read_b64_tr_b16 v[244:245], v38 offset:2048
    ds_read_b64_tr_b16 v[246:247], v38 offset:2056
    v_fma_f32 v240, v156, v176, v177
    v_fma_f32 v241, v157, v176, v177
    v_mfma_f32_16x16x16_bf16 v[196:199], v[136:137], v[74:75], 0
    buffer_load_dwordx4 v249, s[24:27], s80 offen offset:1024 lds
    v_fma_f32 v242, v158, v176, v177
    v_fma_f32 v243, v159, v176, v177
    s_waitcnt vmcnt(12)
    v_mfma_f32_16x16x16_bf16 v[192:195], v[136:137], v[76:77], v[192:195]
    v_exp_f32 v240, v240 clamp
    v_mfma_f32_16x16x16_bf16 v[196:199], v[136:137], v[78:79], v[196:199]
    v_exp_f32 v241, v241 clamp
    s_waitcnt vmcnt(11)
    v_mfma_f32_16x16x16_bf16 v[192:195], v[136:137], v[80:81], v[192:195]
    buffer_load_dwordx4 v250, s[24:27], s80 offen offset:2048 lds
    v_max_f32 v156, v178, v156
    v_max_f32 v157, v178, v157
    v_mfma_f32_16x16x16_bf16 v[196:199], v[136:137], v[82:83], v[196:199]
    v_exp_f32 v242, v242 clamp
    s_waitcnt vmcnt(11)
    v_mfma_f32_16x16x16_bf16 v[192:195], v[136:137], v[84:85], v[192:195]
    v_exp_f32 v243, v243 clamp
    v_mfma_f32_16x16x16_bf16 v[196:199], v[136:137], v[86:87], v[196:199]
    buffer_load_dwordx4 v251, s[24:27], s80 offen offset:3072 lds
    v_max_f32 v158, v178, v158
    v_max_f32 v159, v178, v159
    s_waitcnt lgkmcnt(1)
    v_mfma_f32_16x16x16_bf16 v[200:203], v[244:245], v[180:181], 0
    v_add_f32 v240, v156, v240
    v_add_f32_e64 v241, v157, v241
    s_waitcnt lgkmcnt(0)
    v_mfma_f32_16x16x16_bf16 v[204:207], v[246:247], v[180:181], 0
    v_add_f32 v242, v158, v242
    v_add_f32_e64 v243, v159, v243
    s_waitcnt vmcnt(11)
    v_mfma_f32_16x16x16_bf16 v[192:195], v[136:137], v[88:89], v[192:195]
    s_lshl1_add_u32 m0, s83, 131072
    s_xor_b32 s80, s72, s42
    s_xor_b32 s80, s80, 4
    s_lshl_b32 s80, s80, 7
    s_nop 0
    buffer_load_dwordx4 v248, s[24:27], s80 offen lds
    v_cvt_pk_bf16_f32 v236, v240, v241
    v_cvt_pk_bf16_f32 v237, v242, v243
    v_mfma_f32_16x16x16_bf16 v[196:199], v[136:137], v[90:91], v[196:199]
    v_fma_f32 v240, v160, v176, v177
    v_fma_f32 v241, v161, v176, v177
    s_waitcnt vmcnt(11)
    s_nop 0
    v_mfma_f32_16x16x16_bf16 v[192:195], v[136:137], v[92:93], v[192:195]
    v_fma_f32 v242, v162, v176, v177
    v_fma_f32 v243, v163, v176, v177
    v_mfma_f32_16x16x16_bf16 v[196:199], v[136:137], v[94:95], v[196:199]
    buffer_load_dwordx4 v249, s[24:27], s80 offen offset:1024 lds
    v_exp_f32 v240, v240 clamp
    s_waitcnt vmcnt(11)
    v_mfma_f32_16x16x16_bf16 v[192:195], v[136:137], v[96:97], v[192:195]
    v_exp_f32 v241, v241 clamp
    v_mfma_f32_16x16x16_bf16 v[196:199], v[136:137], v[98:99], v[196:199]
    v_max_f32 v160, v178, v160
    v_max_f32 v161, v178, v161
    s_waitcnt vmcnt(10)
    v_mfma_f32_16x16x16_bf16 v[192:195], v[136:137], v[100:101], v[192:195]
    buffer_load_dwordx4 v250, s[24:27], s80 offen offset:2048 lds
    v_exp_f32 v242, v242 clamp
    v_mfma_f32_16x16x16_bf16 v[196:199], v[136:137], v[102:103], v[196:199]
    v_exp_f32 v243, v243 clamp
    v_max_f32 v162, v178, v162
    v_max_f32 v163, v178, v163
    v_add_f32 v240, v160, v240
    v_add_f32 v241, v161, v241
    v_add_f32 v242, v162, v242
    v_add_f32 v243, v163, v243
    v_cvt_pk_bf16_f32 v226, v240, v241
    v_cvt_pk_bf16_f32 v227, v242, v243
    s_mov_b32 s86, 0
L_gchkA:
    v_add_f32 v6, v200, v202
    v_add_f32_e64 v7, v204, v206
    v_cmp_u_f32 s[92:93], v6, v7
    v_cmp_u_f32 vcc, v192, v196
    s_nop 0
    s_or_b64 vcc, vcc, s[92:93]
    s_cbranch_scc1 L_gslowA
L_gokA:
    ds_write_b128 v38, v[192:195]
    ds_write_b128 v38, v[196:199] offset:1024
    buffer_load_dwordx4 v251, s[24:27], s80 offen offset:3072 lds
    v_pk_fma_f32 v[240:241], v[164:165], v[176:177], v[176:177] op_sel:[0,0,1] op_sel_hi:[1,0,1]
    v_pk_fma_f32 v[242:243], v[166:167], v[176:177], v[176:177] op_sel:[0,0,1] op_sel_hi:[1,0,1]
    v_exp_f32 v240, v240 clamp
    v_exp_f32 v241, v241 clamp
    v_max_f32 v164, v178, v164
    v_max_f32 v165, v178, v165
    v_exp_f32 v242, v242 clamp
    v_exp_f32 v243, v243 clamp
    v_max_f32 v166, v178, v166
    v_max_f32 v167, v178, v167
    v_pk_add_f32 v[240:241], v[164:165], v[240:241]
    v_pk_add_f32 v[242:243], v[166:167], v[242:243]
    v_cvt_pk_bf16_f32 v230, v240, v241
    v_cvt_pk_bf16_f32 v231, v242, v243
    s_add_u32 m0, m0, 4096
    s_add_u32 s80, s80, 32768
    buffer_load_dwordx4 v248, s[24:27], s80 offen lds
    v_pk_fma_f32 v[240:241], v[168:169], v[176:177], v[176:177] op_sel:[0,0,1] op_sel_hi:[1,0,1]
    v_pk_fma_f32 v[242:243], v[170:171], v[176:177], v[176:177] op_sel:[0,0,1] op_sel_hi:[1,0,1]
    v_exp_f32 v240, v240 clamp
    v_exp_f32 v241, v241 clamp
    v_max_f32 v168, v178, v168
    v_max_f32 v169, v178, v169
    v_exp_f32 v242, v242 clamp
    v_exp_f32 v243, v243 clamp
    v_max_f32 v170, v178, v170
    v_max_f32 v171, v178, v171
    v_pk_add_f32 v[240:241], v[168:169], v[240:241]
    s_waitcnt lgkmcnt(0)
    s_barrier
    ds_read_b128 v[208:211], v39
    ds_read_b128 v[212:215], v39 offset:1024
    buffer_load_dwordx4 v249, s[24:27], s80 offen offset:1024 lds
    v_pk_add_f32 v[242:243], v[170:171], v[242:243]
    v_cvt_pk_bf16_f32 v234, v240, v241
    v_cvt_pk_bf16_f32 v235, v242, v243
    v_pk_fma_f32 v[240:241], v[172:173], v[176:177], v[176:177] op_sel:[0,0,1] op_sel_hi:[1,0,1]
    v_pk_fma_f32 v[242:243], v[174:175], v[176:177], v[176:177] op_sel:[0,0,1] op_sel_hi:[1,0,1]
    v_exp_f32 v240, v240 clamp
    v_exp_f32 v241, v241 clamp
    v_max_f32 v172, v178, v172
    v_max_f32 v173, v178, v173
    v_exp_f32 v242, v242 clamp
    v_exp_f32 v243, v243 clamp
    v_max_f32 v174, v178, v174
    v_max_f32 v175, v178, v175
    v_pk_add_f32 v[240:241], v[172:173], v[240:241]
    buffer_load_dwordx4 v250, s[24:27], s80 offen offset:2048 lds
    v_pk_add_f32 v[242:243], v[174:175], v[242:243]
    v_cvt_pk_bf16_f32 v238, v240, v241
    v_cvt_pk_bf16_f32 v239, v242, v243
    v_cvt_pk_bf16_f32 v40, v200, v201
    v_cvt_pk_bf16_f32 v41, v202, v203
    v_cvt_pk_bf16_f32 v42, v204, v205
    v_cvt_pk_bf16_f32 v43, v206, v207
    v_cndmask_b32 v40, v40, 0, s[88:89]
    v_cndmask_b32 v41, v41, 0, s[88:89]
    v_cndmask_b32 v42, 0, v42, s[88:89]
    v_cndmask_b32 v43, 0, v43, s[88:89]
    s_waitcnt lgkmcnt(1)
    v_pk_add_f32 v[192:193], v[192:193], v[208:209]
    v_pk_add_f32 v[194:195], v[194:195], v[210:211]
    s_waitcnt lgkmcnt(0)
    v_pk_add_f32 v[196:197], v[196:197], v[212:213]
    v_pk_add_f32 v[198:199], v[198:199], v[214:215]
    s_mov_b32 s56, 0
    s_nop 0
    s_atomic_add s56, s[48:49], 0 glc
    buffer_load_dwordx4 v251, s[24:27], s80 offen offset:3072 lds
    v_mfma_f32_16x16x32_bf16 v[72:75], v[40:43], v[224:227], v[140:143]
    v_cvt_pk_bf16_f32 v48, v192, v193
    v_cvt_pk_bf16_f32 v49, v194, v195
    v_mfma_f32_16x16x32_bf16 v[84:87], v[40:43], v[228:231], v[140:143]
    v_cvt_pk_bf16_f32 v50, v196, v197
    v_cvt_pk_bf16_f32 v51, v198, v199
    v_mfma_f32_16x16x32_bf16 v[96:99], v[40:43], v[232:235], v[140:143]
    v_mfma_f32_16x16x32_bf16 v[108:111], v[40:43], v[236:239], v[140:143]
    s_lshl1_add_u32 m0, s83, 65536
    s_xor_b32 s80, s72, s42
    s_xor_b32 s80, s80, 6
    s_lshl_b32 s80, s80, 7
    buffer_load_dwordx4 v248, s[24:27], s80 offen lds
    v_mfma_f32_16x16x16_bf16 v[76:79], v[48:49], v[224:225], 0
    v_mfma_f32_16x16x16_bf16 v[80:83], v[50:51], v[226:227], 0
    v_mfma_f32_16x16x16_bf16 v[88:91], v[48:49], v[228:229], 0
    v_rcp_f32 v72, v72
    v_mfma_f32_16x16x16_bf16 v[92:95], v[50:51], v[230:231], 0
    buffer_load_dwordx4 v249, s[24:27], s80 offen offset:1024 lds
    v_rcp_f32_e64 v73, v73
    v_mfma_f32_16x16x16_bf16 v[100:103], v[48:49], v[232:233], 0
    v_rcp_f32_e64 v84, v84
    v_mfma_f32_16x16x16_bf16 v[104:107], v[50:51], v[234:235], 0
    v_rcp_f32_e64 v85, v85
    v_mfma_f32_16x16x16_bf16 v[112:115], v[48:49], v[236:237], 0
    buffer_load_dwordx4 v250, s[24:27], s80 offen offset:2048 lds
    v_rcp_f32_e64 v96, v96
    v_mfma_f32_16x16x16_bf16 v[116:119], v[50:51], v[238:239], 0
    v_rcp_f32 v97, v97
    v_rcp_f32 v108, v108
    v_rcp_f32_e64 v109, v109
    v_pk_mul_f32 v[76:77], v[72:73], v[76:77] op_sel:[0,0] op_sel_hi:[0,1]
    v_pk_mul_f32 v[78:79], v[72:73], v[78:79] op_sel:[0,0] op_sel_hi:[0,1]
    v_pk_mul_f32 v[80:81], v[72:73], v[80:81] op_sel:[1,0] op_sel_hi:[1,1]
    v_pk_mul_f32 v[82:83], v[72:73], v[82:83] op_sel:[1,0] op_sel_hi:[1,1]
    v_cvt_pk_bf16_f32 v76, v76, v77
    v_cvt_pk_bf16_f32 v77, v78, v79
    v_cvt_pk_bf16_f32 v78, v80, v81
    buffer_load_dwordx4 v251, s[24:27], s80 offen offset:3072 lds
    v_cvt_pk_bf16_f32 v79, v82, v83
    buffer_store_dwordx4 v[76:79], v3, s[12:15], s87 offen offset:0 sc1
    v_pk_mul_f32 v[88:89], v[84:85], v[88:89] op_sel:[0,0] op_sel_hi:[0,1]
    v_pk_mul_f32 v[90:91], v[84:85], v[90:91] op_sel:[0,0] op_sel_hi:[0,1]
    v_pk_mul_f32 v[92:93], v[84:85], v[92:93] op_sel:[1,0] op_sel_hi:[1,1]
    v_pk_mul_f32 v[94:95], v[84:85], v[94:95] op_sel:[1,0] op_sel_hi:[1,1]
    v_cvt_pk_bf16_f32 v88, v88, v89
    v_cvt_pk_bf16_f32 v89, v90, v91
    v_cvt_pk_bf16_f32 v90, v92, v93
    v_cvt_pk_bf16_f32 v91, v94, v95
    buffer_store_dwordx4 v[88:91], v3, s[12:15], s87 offen offset:1024 sc1
    v_pk_mul_f32 v[100:101], v[96:97], v[100:101] op_sel:[0,0] op_sel_hi:[0,1]
    v_pk_mul_f32 v[102:103], v[96:97], v[102:103] op_sel:[0,0] op_sel_hi:[0,1]
    v_pk_mul_f32 v[104:105], v[96:97], v[104:105] op_sel:[1,0] op_sel_hi:[1,1]
    v_pk_mul_f32 v[106:107], v[96:97], v[106:107] op_sel:[1,0] op_sel_hi:[1,1]
    v_cvt_pk_bf16_f32 v100, v100, v101
    v_cvt_pk_bf16_f32 v101, v102, v103
    v_cvt_pk_bf16_f32 v102, v104, v105
    v_cvt_pk_bf16_f32 v103, v106, v107
    buffer_store_dwordx4 v[100:103], v3, s[12:15], s84 offen offset:0 sc1
    v_pk_mul_f32 v[112:113], v[108:109], v[112:113] op_sel:[0,0] op_sel_hi:[0,1]
    v_pk_mul_f32 v[114:115], v[108:109], v[114:115] op_sel:[0,0] op_sel_hi:[0,1]
    v_pk_mul_f32 v[116:117], v[108:109], v[116:117] op_sel:[1,0] op_sel_hi:[1,1]
    v_pk_mul_f32 v[118:119], v[108:109], v[118:119] op_sel:[1,0] op_sel_hi:[1,1]
    v_cvt_pk_bf16_f32 v112, v112, v113
    v_cvt_pk_bf16_f32 v113, v114, v115
    v_cvt_pk_bf16_f32 v114, v116, v117
    v_cvt_pk_bf16_f32 v115, v118, v119
    buffer_store_dwordx4 v[112:115], v3, s[12:15], s84 offen offset:1024 sc1
    s_waitcnt lgkmcnt(0)
    s_mov_b32 s86, 0
    s_add_u32 s56, s56, 1
    s_lshr_b32 s57, s56, s59
    s_bitcmp1_b32 s57, 0
    s_cbranch_scc0 L_p0Aslow
    s_add_u32 s78, s46, 0
    s_nop 0
    buffer_load_dwordx4 a[128:131], v3, s[12:15], s78 offen offset:0 sc1
    buffer_load_dwordx4 a[132:135], v3, s[12:15], s78 offen offset:2048 sc1
    buffer_load_dwordx4 a[136:139], v3, s[12:15], s78 offen offset:1024 sc1
    buffer_load_dwordx4 a[140:143], v3, s[12:15], s78 offen offset:3072 sc1
    s_add_u32 s78, s46, 4096
    buffer_load_dwordx4 a[144:147], v3, s[12:15], s78 offen offset:0 sc1
    buffer_load_dwordx4 a[148:151], v3, s[12:15], s78 offen offset:2048 sc1
    buffer_load_dwordx4 a[152:155], v3, s[12:15], s78 offen offset:1024 sc1
    buffer_load_dwordx4 a[156:159], v3, s[12:15], s78 offen offset:3072 sc1
    ds_read_b64 v[160:161], v32 offset:4096
    ds_read_b64 v[162:163], v32 offset:4224
    ds_read_b64 v[164:165], v32 offset:4352
    ds_read_b64 v[166:167], v32 offset:4480
    ds_read_b64 v[168:169], v33 offset:6144
    s_lshl_b32 s81, s52, 8
    s_add_u32 s74, s81, 4096
    v_add_u32 v16, 32768, v179
    s_waitcnt lgkmcnt(4)
    v_lshlrev_b32_e64 v144, 16, v160
    v_and_b32 v145, 0xffff0000, v160
    v_lshlrev_b32_e64 v146, 16, v161
    v_and_b32 v147, 0xffff0000, v161
    s_waitcnt lgkmcnt(3)
    v_lshlrev_b32 v148, 16, v162
    v_and_b32 v149, 0xffff0000, v162
    v_lshlrev_b32_e64 v150, 16, v163
    v_and_b32 v151, 0xffff0000, v163
    s_waitcnt lgkmcnt(2)
    v_lshlrev_b32 v152, 16, v164
    v_and_b32 v153, 0xffff0000, v164
    v_lshlrev_b32_e64 v154, 16, v165
    v_and_b32 v155, 0xffff0000, v165
    s_waitcnt lgkmcnt(1)
    v_lshlrev_b32 v156, 16, v166
    v_and_b32 v157, 0xffff0000, v166
    v_lshlrev_b32_e64 v158, 16, v167
    v_and_b32 v159, 0xffff0000, v167
    s_waitcnt lgkmcnt(0)
    v_lshlrev_b32 v170, 16, v169
    v_and_b32 v171, 0xffff0000, v169
    v_and_b32 v169, 0xffff0000, v168
    v_lshlrev_b32_e64 v168, 16, v168
    v_pk_mul_f32 v[144:145], v[144:145], v[168:169]
    v_pk_mul_f32 v[146:147], v[146:147], v[170:171]
    v_pk_mul_f32 v[148:149], v[148:149], v[168:169]
    v_pk_mul_f32 v[150:151], v[150:151], v[170:171]
    v_pk_mul_f32 v[152:153], v[152:153], v[168:169]
    v_pk_mul_f32 v[154:155], v[154:155], v[170:171]
    v_pk_mul_f32 v[156:157], v[156:157], v[168:169]
    v_pk_mul_f32 v[158:159], v[158:159], v[170:171]
    s_waitcnt vmcnt(16)
    s_waitcnt vmcnt(8)
    s_barrier
    s_atomic_add s60, s[50:51], 0
    s_atomic_add s60, s[50:51], 128
    s_atomic_add s60, s[50:51], 256
    s_atomic_add s60, s[50:51], 384
L_p0Ajoin:
    s_andn2_b32 s56, 15, s57
    s_cbranch_scc0 L_p0Aall
    s_mov_b32 s56, 0
    s_atomic_add s56, s[48:49], 0 glc
L_p0Aall:
    ds_read_b64 v[40:41], v220 offset:0
    ds_read_b64 v[42:43], v220 offset:8192
    ds_read_b64 v[44:45], v221 offset:0
    ds_read_b64 v[46:47], v221 offset:8192
    ds_read_b64 v[48:49], v220 offset:2048
    ds_read_b64 v[50:51], v220 offset:10240
    ds_read_b64 v[52:53], v221 offset:2048
    ds_read_b64 v[54:55], v221 offset:10240
    ds_read_b64 v[56:57], v220 offset:4096
    ds_read_b64 v[58:59], v220 offset:12288
    ds_read_b64 v[60:61], v221 offset:4096
    ds_read_b64 v[62:63], v221 offset:12288
    s_add_u32 s78, s46, 8192
    s_waitcnt vmcnt(7) lgkmcnt(10)
    v_mfma_f32_16x16x32_bf16 v[72:75], a[128:131], v[40:43], 0
    ds_read_b64 v[64:65], v220 offset:6144
    s_bitcmp1_b32 s57, 1
    s_cbranch_scc0 L_p1Aslow
L_p1Aok:
    buffer_load_dwordx4 a[160:163], v3, s[12:15], s78 offen offset:0 sc1
    s_waitcnt vmcnt(7) lgkmcnt(9)
    v_mfma_f32_16x16x32_bf16 v[72:75], a[132:135], v[44:47], v[72:75]
    ds_read_b64 v[66:67], v220 offset:14336
    s_waitcnt vmcnt(5)
    s_nop 0
    v_mfma_f32_16x16x32_bf16 v[88:91], a[136:139], v[40:43], 0
    ds_read_b64 v[68:69], v221 offset:6144
    s_add_u32 m0, m0, 4096
    s_add_u32 s80, s80, 32768
    buffer_load_dwordx4 v248, s[24:27], s80 offen lds
    v_mfma_f32_16x16x32_bf16 v[88:91], a[140:143], v[44:47], v[88:91]
    ds_read_b64 v[70:71], v221 offset:14336
    s_waitcnt lgkmcnt(10)
    v_mfma_f32_16x16x32_bf16 v[76:79], a[128:131], v[48:51], 0
    ds_read_b64 v[40:41], v222 offset:0
    buffer_load_dwordx4 a[164:167], v3, s[12:15], s78 offen offset:2048 sc1
    s_waitcnt lgkmcnt(9)
    v_mfma_f32_16x16x32_bf16 v[76:79], a[132:135], v[52:55], v[76:79]
    ds_read_b64 v[42:43], v222 offset:8192
    v_mfma_f32_16x16x32_bf16 v[92:95], a[136:139], v[48:51], 0
    ds_read_b64 v[44:45], v223 offset:0
    buffer_load_dwordx4 v249, s[24:27], s80 offen offset:1024 lds
    v_mfma_f32_16x16x32_bf16 v[92:95], a[140:143], v[52:55], v[92:95]
    ds_read_b64 v[46:47], v223 offset:8192
    s_waitcnt lgkmcnt(10)
    v_mfma_f32_16x16x32_bf16 v[80:83], a[128:131], v[56:59], 0
    ds_read_b64 v[48:49], v222 offset:2048
    buffer_load_dwordx4 a[168:171], v3, s[12:15], s78 offen offset:1024 sc1
    s_waitcnt lgkmcnt(8)
    v_mfma_f32_16x16x32_bf16 v[80:83], a[132:135], v[60:63], v[80:83]
    ds_read_b64 v[50:51], v222 offset:10240
    v_mfma_f32_16x16x32_bf16 v[96:99], a[136:139], v[56:59], 0
    ds_read_b64 v[52:53], v223 offset:2048
    buffer_load_dwordx4 v250, s[24:27], s80 offen offset:2048 lds
    v_mfma_f32_16x16x32_bf16 v[96:99], a[140:143], v[60:63], v[96:99]
    ds_read_b64 v[54:55], v223 offset:10240
    s_waitcnt lgkmcnt(8)
    s_nop 0
    v_mfma_f32_16x16x32_bf16 v[84:87], a[128:131], v[64:67], 0
    ds_read_b64 v[56:57], v222 offset:4096
    buffer_load_dwordx4 a[172:175], v3, s[12:15], s78 offen offset:3072 sc1
    v_mfma_f32_16x16x32_bf16 v[84:87], a[132:135], v[68:71], v[84:87]
    ds_read_b64 v[58:59], v222 offset:12288
    s_add_u32 s78, s46, 12288
    v_mfma_f32_16x16x32_bf16 v[100:103], a[136:139], v[64:67], 0
    ds_read_b64 v[60:61], v223 offset:4096
    buffer_load_dwordx4 v251, s[24:27], s80 offen offset:3072 lds
    v_mfma_f32_16x16x32_bf16 v[100:103], a[140:143], v[68:71], v[100:103]
    ds_read_b64 v[62:63], v223 offset:12288
    s_waitcnt vmcnt(10) lgkmcnt(8)
    s_nop 0
    v_mfma_f32_16x16x32_bf16 v[72:75], a[144:147], v[40:43], v[72:75]
    ds_read_b64 v[64:65], v222 offset:6144
    buffer_load_dwordx4 a[176:179], v3, s[12:15], s78 offen offset:0 sc1
    v_mfma_f32_16x16x32_bf16 v[72:75], a[148:151], v[44:47], v[72:75]
    ds_read_b64 v[66:67], v222 offset:14336
    s_waitcnt vmcnt(9)
    v_mfma_f32_16x16x32_bf16 v[88:91], a[152:155], v[40:43], v[88:91]
    ds_read_b64 v[68:69], v223 offset:6144
    v_mfma_f32_16x16x32_bf16 v[88:91], a[156:159], v[44:47], v[88:91]
    ds_read_b64 v[70:71], v223 offset:14336
    s_waitcnt lgkmcnt(8)
    v_mfma_f32_16x16x32_bf16 v[76:79], a[144:147], v[48:51], v[76:79]
    ds_read_b64 v[40:41], v220 offset:16384
    buffer_load_dwordx4 a[180:183], v3, s[12:15], s78 offen offset:2048 sc1
    v_mfma_f32_16x16x32_bf16 v[76:79], a[148:151], v[52:55], v[76:79]
    ds_read_b64 v[42:43], v220 offset:24576
    v_mfma_f32_16x16x32_bf16 v[92:95], a[152:155], v[48:51], v[92:95]
    ds_read_b64 v[44:45], v221 offset:16384
    v_mfma_f32_16x16x32_bf16 v[92:95], a[156:159], v[52:55], v[92:95]
    ds_read_b64 v[46:47], v221 offset:24576
    s_waitcnt lgkmcnt(8)
    s_nop 0
    v_mfma_f32_16x16x32_bf16 v[80:83], a[144:147], v[56:59], v[80:83]
    ds_read_b64 v[48:49], v220 offset:18432
    buffer_load_dwordx4 a[184:187], v3, s[12:15], s78 offen offset:1024 sc1
    v_mfma_f32_16x16x32_bf16 v[80:83], a[148:151], v[60:63], v[80:83]
    ds_read_b64 v[50:51], v220 offset:26624
    v_mfma_f32_16x16x32_bf16 v[96:99], a[152:155], v[56:59], v[96:99]
    ds_read_b64 v[52:53], v221 offset:18432
    v_mfma_f32_16x16x32_bf16 v[96:99], a[156:159], v[60:63], v[96:99]
    ds_read_b64 v[54:55], v221 offset:26624
    s_waitcnt lgkmcnt(8)
    s_nop 0
    v_mfma_f32_16x16x32_bf16 v[84:87], a[144:147], v[64:67], v[84:87]
    ds_read_b64 v[56:57], v220 offset:20480
    buffer_load_dwordx4 a[188:191], v3, s[12:15], s78 offen offset:3072 sc1
    v_mfma_f32_16x16x32_bf16 v[84:87], a[148:151], v[68:71], v[84:87]
    ds_read_b64 v[58:59], v220 offset:28672
    s_add_u32 s78, s46, 16384
    v_mfma_f32_16x16x32_bf16 v[100:103], a[152:155], v[64:67], v[100:103]
    ds_read_b64 v[60:61], v221 offset:20480
    v_mfma_f32_16x16x32_bf16 v[100:103], a[156:159], v[68:71], v[100:103]
    ds_read_b64 v[62:63], v221 offset:28672
    s_waitcnt vmcnt(9) lgkmcnt(8)
    v_mfma_f32_16x16x32_bf16 v[72:75], a[160:163], v[40:43], v[72:75]
    ds_read_b64 v[64:65], v220 offset:22528
    s_bitcmp1_b32 s57, 2
    s_cbranch_scc0 L_p2Aslow
L_p2Aok:
    buffer_load_dwordx4 a[192:195], v3, s[12:15], s78 offen offset:0 sc1
    v_mfma_f32_16x16x32_bf16 v[72:75], a[164:167], v[44:47], v[72:75]
    ds_read_b64 v[66:67], v220 offset:30720
    s_waitcnt vmcnt(6)
    v_mfma_f32_16x16x32_bf16 v[88:91], a[168:171], v[40:43], v[88:91]
    ds_read_b64 v[68:69], v221 offset:22528
    v_mfma_f32_16x16x32_bf16 v[88:91], a[172:175], v[44:47], v[88:91]
    ds_read_b64 v[70:71], v221 offset:30720
    s_waitcnt lgkmcnt(8)
    s_nop 0
    v_mfma_f32_16x16x32_bf16 v[76:79], a[160:163], v[48:51], v[76:79]
    ds_read_b64 v[40:41], v222 offset:16384
    buffer_load_dwordx4 a[196:199], v3, s[12:15], s78 offen offset:2048 sc1
    v_mfma_f32_16x16x32_bf16 v[76:79], a[164:167], v[52:55], v[76:79]
    ds_read_b64 v[42:43], v222 offset:24576
    v_mfma_f32_16x16x32_bf16 v[92:95], a[168:171], v[48:51], v[92:95]
    ds_read_b64 v[44:45], v223 offset:16384
    v_mfma_f32_16x16x32_bf16 v[92:95], a[172:175], v[52:55], v[92:95]
    ds_read_b64 v[46:47], v223 offset:24576
    s_waitcnt lgkmcnt(8)
    s_nop 0
    v_mfma_f32_16x16x32_bf16 v[80:83], a[160:163], v[56:59], v[80:83]
    ds_read_b64 v[48:49], v222 offset:18432
    buffer_load_dwordx4 a[200:203], v3, s[12:15], s78 offen offset:1024 sc1
    v_mfma_f32_16x16x32_bf16 v[80:83], a[164:167], v[60:63], v[80:83]
    ds_read_b64 v[50:51], v222 offset:26624
    v_mfma_f32_16x16x32_bf16 v[96:99], a[168:171], v[56:59], v[96:99]
    ds_read_b64 v[52:53], v223 offset:18432
    v_mfma_f32_16x16x32_bf16 v[96:99], a[172:175], v[60:63], v[96:99]
    ds_read_b64 v[54:55], v223 offset:26624
    s_waitcnt lgkmcnt(8)
    s_nop 0
    v_mfma_f32_16x16x32_bf16 v[84:87], a[160:163], v[64:67], v[84:87]
    ds_read_b64 v[56:57], v222 offset:20480
    buffer_load_dwordx4 a[204:207], v3, s[12:15], s78 offen offset:3072 sc1
    v_mfma_f32_16x16x32_bf16 v[84:87], a[164:167], v[68:71], v[84:87]
    ds_read_b64 v[58:59], v222 offset:28672
    s_add_u32 s78, s46, 20480
    v_mfma_f32_16x16x32_bf16 v[100:103], a[168:171], v[64:67], v[100:103]
    ds_read_b64 v[60:61], v223 offset:20480
    v_mfma_f32_16x16x32_bf16 v[100:103], a[172:175], v[68:71], v[100:103]
    ds_read_b64 v[62:63], v223 offset:28672
    s_waitcnt vmcnt(6) lgkmcnt(8)
    v_mfma_f32_16x16x32_bf16 v[72:75], a[176:179], v[40:43], v[72:75]
    s_barrier
    ds_read_b64 v[64:65], v222 offset:22528
    buffer_load_dwordx4 a[208:211], v3, s[12:15], s78 offen offset:0 sc1
    v_mfma_f32_16x16x32_bf16 v[72:75], a[180:183], v[44:47], v[72:75]
    ds_read_b64 v[66:67], v222 offset:30720
    s_waitcnt vmcnt(5)
    v_mfma_f32_16x16x32_bf16 v[88:91], a[184:187], v[40:43], v[88:91]
    ds_read_b64 v[68:69], v223 offset:22528
    v_mfma_f32_16x16x32_bf16 v[88:91], a[188:191], v[44:47], v[88:91]
    ds_read_b64 v[70:71], v223 offset:30720
    s_waitcnt lgkmcnt(8)
    v_mfma_f32_16x16x32_bf16 v[76:79], a[176:179], v[48:51], v[76:79]
    ds_read_b64 v[40:41], v216 offset:0
    buffer_load_dwordx4 a[212:215], v3, s[12:15], s78 offen offset:2048 sc1
    v_mfma_f32_16x16x32_bf16 v[76:79], a[180:183], v[52:55], v[76:79]
    ds_read_b64 v[42:43], v216 offset:8192
    v_mfma_f32_16x16x32_bf16 v[92:95], a[184:187], v[48:51], v[92:95]
    ds_read_b64 v[44:45], v217 offset:0
    v_mfma_f32_16x16x32_bf16 v[92:95], a[188:191], v[52:55], v[92:95]
    ds_read_b64 v[46:47], v217 offset:8192
    s_waitcnt lgkmcnt(8)
    s_nop 0
    v_mfma_f32_16x16x32_bf16 v[80:83], a[176:179], v[56:59], v[80:83]
    ds_read_b64 v[48:49], v216 offset:2048
    buffer_load_dwordx4 a[216:219], v3, s[12:15], s78 offen offset:1024 sc1
    v_mfma_f32_16x16x32_bf16 v[80:83], a[180:183], v[60:63], v[80:83]
    ds_read_b64 v[50:51], v216 offset:10240
    v_mfma_f32_16x16x32_bf16 v[96:99], a[184:187], v[56:59], v[96:99]
    ds_read_b64 v[52:53], v217 offset:2048
    v_mfma_f32_16x16x32_bf16 v[96:99], a[188:191], v[60:63], v[96:99]
    ds_read_b64 v[54:55], v217 offset:10240
    s_waitcnt lgkmcnt(8)
    s_nop 0
    v_mfma_f32_16x16x32_bf16 v[84:87], a[176:179], v[64:67], v[84:87]
    ds_read_b64 v[56:57], v216 offset:4096
    buffer_load_dwordx4 a[220:223], v3, s[12:15], s78 offen offset:3072 sc1
    v_mfma_f32_16x16x32_bf16 v[84:87], a[180:183], v[68:71], v[84:87]
    ds_read_b64 v[58:59], v216 offset:12288
    s_add_u32 s78, s46, 24576
    v_mfma_f32_16x16x32_bf16 v[100:103], a[184:187], v[64:67], v[100:103]
    ds_read_b64 v[60:61], v217 offset:4096
    v_mfma_f32_16x16x32_bf16 v[100:103], a[188:191], v[68:71], v[100:103]
    ds_read_b64 v[62:63], v217 offset:12288
    s_waitcnt vmcnt(6) lgkmcnt(8)
    v_mfma_f32_16x16x32_bf16 v[72:75], a[192:195], v[40:43], v[72:75]
    ds_read_b64 v[64:65], v216 offset:6144
    s_bitcmp1_b32 s57, 3
    s_cbranch_scc0 L_p3Aslow
L_p3Aok:
    buffer_load_dwordx4 a[224:227], v3, s[12:15], s78 offen offset:0 sc1
    v_mfma_f32_16x16x32_bf16 v[72:75], a[196:199], v[44:47], v[72:75]
    ds_read_b64 v[66:67], v216 offset:14336
    s_mov_b32 s56, 0
    s_atomic_add s56, s[48:49], 0 glc
    s_waitcnt vmcnt(5)
    v_mfma_f32_16x16x32_bf16 v[88:91], a[200:203], v[40:43], v[88:91]
    ds_read_b64 v[68:69], v217 offset:6144
    v_mfma_f32_16x16x32_bf16 v[88:91], a[204:207], v[44:47], v[88:91]
    ds_read_b64 v[70:71], v217 offset:14336
    s_waitcnt lgkmcnt(8)
    v_mfma_f32_16x16x32_bf16 v[76:79], a[192:195], v[48:51], v[76:79]
    ds_read_b64 v[40:41], v218 offset:0
    buffer_load_dwordx4 a[228:231], v3, s[12:15], s78 offen offset:2048 sc1
    v_mfma_f32_16x16x32_bf16 v[76:79], a[196:199], v[52:55], v[76:79]
    ds_read_b64 v[42:43], v218 offset:8192
    v_mfma_f32_16x16x32_bf16 v[92:95], a[200:203], v[48:51], v[92:95]
    ds_read_b64 v[44:45], v219 offset:0
    v_mfma_f32_16x16x32_bf16 v[92:95], a[204:207], v[52:55], v[92:95]
    ds_read_b64 v[46:47], v219 offset:8192
    s_waitcnt lgkmcnt(8)
    s_nop 0
    v_mfma_f32_16x16x32_bf16 v[80:83], a[192:195], v[56:59], v[80:83]
    ds_read_b64 v[48:49], v218 offset:2048
    buffer_load_dwordx4 a[232:235], v3, s[12:15], s78 offen offset:1024 sc1
    v_mfma_f32_16x16x32_bf16 v[80:83], a[196:199], v[60:63], v[80:83]
    ds_read_b64 v[50:51], v218 offset:10240
    v_mfma_f32_16x16x32_bf16 v[96:99], a[200:203], v[56:59], v[96:99]
    ds_read_b64 v[52:53], v219 offset:2048
    v_mfma_f32_16x16x32_bf16 v[96:99], a[204:207], v[60:63], v[96:99]
    ds_read_b64 v[54:55], v219 offset:10240
    s_waitcnt lgkmcnt(8)
    s_nop 0
    v_mfma_f32_16x16x32_bf16 v[84:87], a[192:195], v[64:67], v[84:87]
    ds_read_b64 v[56:57], v218 offset:4096
    buffer_load_dwordx4 a[236:239], v3, s[12:15], s78 offen offset:3072 sc1
    v_mfma_f32_16x16x32_bf16 v[84:87], a[196:199], v[68:71], v[84:87]
    ds_read_b64 v[58:59], v218 offset:12288
    s_add_u32 s78, s46, 28672
    v_mfma_f32_16x16x32_bf16 v[100:103], a[200:203], v[64:67], v[100:103]
    ds_read_b64 v[60:61], v219 offset:4096
    v_mfma_f32_16x16x32_bf16 v[100:103], a[204:207], v[68:71], v[100:103]
    ds_read_b64 v[62:63], v219 offset:12288
    s_waitcnt vmcnt(6) lgkmcnt(8)
    s_nop 0
    v_mfma_f32_16x16x32_bf16 v[72:75], a[208:211], v[40:43], v[72:75]
    ds_read_b64 v[64:65], v218 offset:6144
    buffer_load_dwordx4 a[240:243], v3, s[12:15], s78 offen offset:0 sc1
    v_mfma_f32_16x16x32_bf16 v[72:75], a[212:215], v[44:47], v[72:75]
    ds_read_b64 v[66:67], v218 offset:14336
    s_waitcnt vmcnt(5)
    v_mfma_f32_16x16x32_bf16 v[88:91], a[216:219], v[40:43], v[88:91]
    ds_read_b64 v[68:69], v219 offset:6144
    v_mfma_f32_16x16x32_bf16 v[88:91], a[220:223], v[44:47], v[88:91]
    ds_read_b64 v[70:71], v219 offset:14336
    s_waitcnt lgkmcnt(8)
    v_mfma_f32_16x16x32_bf16 v[76:79], a[208:211], v[48:51], v[76:79]
    ds_read_b64 v[40:41], v216 offset:16384
    buffer_load_dwordx4 a[244:247], v3, s[12:15], s78 offen offset:2048 sc1
    v_mfma_f32_16x16x32_bf16 v[76:79], a[212:215], v[52:55], v[76:79]
    ds_read_b64 v[42:43], v216 offset:24576
    v_mfma_f32_16x16x32_bf16 v[92:95], a[216:219], v[48:51], v[92:95]
    ds_read_b64 v[44:45], v217 offset:16384
    v_mfma_f32_16x16x32_bf16 v[92:95], a[220:223], v[52:55], v[92:95]
    ds_read_b64 v[46:47], v217 offset:24576
    s_waitcnt lgkmcnt(8)
    s_nop 0
    v_mfma_f32_16x16x32_bf16 v[80:83], a[208:211], v[56:59], v[80:83]
    ds_read_b64 v[48:49], v216 offset:18432
    buffer_load_dwordx4 a[248:251], v3, s[12:15], s78 offen offset:1024 sc1
    v_mfma_f32_16x16x32_bf16 v[80:83], a[212:215], v[60:63], v[80:83]
    ds_read_b64 v[50:51], v216 offset:26624
    v_mfma_f32_16x16x32_bf16 v[96:99], a[216:219], v[56:59], v[96:99]
    ds_read_b64 v[52:53], v217 offset:18432
    v_mfma_f32_16x16x32_bf16 v[96:99], a[220:223], v[60:63], v[96:99]
    ds_read_b64 v[54:55], v217 offset:26624
    s_waitcnt lgkmcnt(8)
    s_nop 0
    v_mfma_f32_16x16x32_bf16 v[84:87], a[208:211], v[64:67], v[84:87]
    ds_read_b64 v[56:57], v216 offset:20480
    buffer_load_dwordx4 a[252:255], v3, s[12:15], s78 offen offset:3072 sc1
    v_mfma_f32_16x16x32_bf16 v[84:87], a[212:215], v[68:71], v[84:87]
    ds_read_b64 v[58:59], v216 offset:28672
    s_add_u32 s78, s46, 32768
    v_mfma_f32_16x16x32_bf16 v[100:103], a[216:219], v[64:67], v[100:103]
    ds_read_b64 v[60:61], v217 offset:20480
    v_mfma_f32_16x16x32_bf16 v[100:103], a[220:223], v[68:71], v[100:103]
    ds_read_b64 v[62:63], v217 offset:28672
    s_waitcnt vmcnt(6) lgkmcnt(8)
    v_mfma_f32_16x16x32_bf16 v[72:75], a[224:227], v[40:43], v[72:75]
    ds_read_b64 v[64:65], v216 offset:22528
    s_waitcnt lgkmcnt(0)
    s_mov_b32 s86, 0
    s_add_u32 s56, s56, 1
    s_and_b32 s56, s56, s61
    s_cmp_eq_u32 s56, s61
    s_cbranch_scc0 L_paAslow
    s_lshl1_add_u32 m0, s83, 6400
    s_nop 0
    buffer_load_dword v139, s[12:15], s47 offen sc1 lds
    s_lshl_b32 m0, s83, 1
    buffer_load_dwordx4 a[128:131], v3, s[12:15], s78 offen offset:0 sc1
    v_mfma_f32_16x16x32_bf16 v[72:75], a[228:231], v[44:47], v[72:75]
    ds_read_b64 v[66:67], v216 offset:30720
    s_waitcnt vmcnt(6)
    v_mfma_f32_16x16x32_bf16 v[88:91], a[232:235], v[40:43], v[88:91]
    ds_read_b64 v[68:69], v217 offset:22528
    v_mfma_f32_16x16x32_bf16 v[88:91], a[236:239], v[44:47], v[88:91]
    ds_read_b64 v[70:71], v217 offset:30720
    v_mfma_f32_16x16x32_bf16 v[76:79], a[224:227], v[48:51], v[76:79]
    ds_read_b64 v[40:41], v218 offset:16384
    buffer_load_dwordx4 a[132:135], v3, s[12:15], s78 offen offset:2048 sc1
    v_mfma_f32_16x16x32_bf16 v[76:79], a[228:231], v[52:55], v[76:79]
    ds_read_b64 v[42:43], v218 offset:24576
    s_add_u32 s78, s46, 36864
    v_mfma_f32_16x16x32_bf16 v[92:95], a[232:235], v[48:51], v[92:95]
    ds_read_b64 v[44:45], v219 offset:16384
    v_mfma_f32_16x16x32_bf16 v[92:95], a[236:239], v[52:55], v[92:95]
    ds_read_b64 v[46:47], v219 offset:24576
    v_mfma_f32_16x16x32_bf16 v[80:83], a[224:227], v[56:59], v[80:83]
    ds_read_b64 v[48:49], v218 offset:18432
    buffer_load_dwordx4 a[136:139], v3, s[12:15], s78 offen offset:0 sc1
    v_mfma_f32_16x16x32_bf16 v[80:83], a[228:231], v[60:63], v[80:83]
    ds_read_b64 v[50:51], v218 offset:26624
    v_mfma_f32_16x16x32_bf16 v[96:99], a[232:235], v[56:59], v[96:99]
    ds_read_b64 v[52:53], v219 offset:18432
    v_mfma_f32_16x16x32_bf16 v[96:99], a[236:239], v[60:63], v[96:99]
    ds_read_b64 v[54:55], v219 offset:26624
    s_waitcnt lgkmcnt(8)
    s_nop 0
    v_mfma_f32_16x16x32_bf16 v[84:87], a[224:227], v[64:67], v[84:87]
    ds_read_b64 v[56:57], v218 offset:20480
    buffer_load_dwordx4 a[140:143], v3, s[12:15], s78 offen offset:2048 sc1
    v_mfma_f32_16x16x32_bf16 v[84:87], a[228:231], v[68:71], v[84:87]
    ds_read_b64 v[58:59], v218 offset:28672
    s_add_u32 s78, s46, 40960
    v_mfma_f32_16x16x32_bf16 v[100:103], a[232:235], v[64:67], v[100:103]
    ds_read_b64 v[60:61], v219 offset:20480
    v_mfma_f32_16x16x32_bf16 v[100:103], a[236:239], v[68:71], v[100:103]
    ds_read_b64 v[62:63], v219 offset:28672
    s_waitcnt vmcnt(7) lgkmcnt(8)
    s_nop 0
    v_mfma_f32_16x16x32_bf16 v[72:75], a[240:243], v[40:43], v[72:75]
    ds_read_b64 v[64:65], v218 offset:22528
    buffer_load_dwordx4 a[144:147], v3, s[12:15], s78 offen offset:0 sc1
    v_mfma_f32_16x16x32_bf16 v[72:75], a[244:247], v[44:47], v[72:75]
    ds_read_b64 v[66:67], v218 offset:30720
    s_waitcnt vmcnt(6)
    v_mfma_f32_16x16x32_bf16 v[88:91], a[248:251], v[40:43], v[88:91]
    ds_read_b64 v[68:69], v219 offset:22528
    v_mfma_f32_16x16x32_bf16 v[88:91], a[252:255], v[44:47], v[88:91]
    ds_read_b64 v[70:71], v219 offset:30720
    s_waitcnt lgkmcnt(8)
    v_mfma_f32_16x16x32_bf16 v[76:79], a[240:243], v[48:51], v[76:79]
    buffer_load_dwordx4 a[148:151], v3, s[12:15], s78 offen offset:2048 sc1
    s_add_u32 s78, s46, 45056
    v_mfma_f32_16x16x32_bf16 v[76:79], a[244:247], v[52:55], v[76:79]
    v_mfma_f32_16x16x32_bf16 v[92:95], a[248:251], v[48:51], v[92:95]
    v_mfma_f32_16x16x32_bf16 v[92:95], a[252:255], v[52:55], v[92:95]
    s_waitcnt lgkmcnt(4)
    s_nop 0
    v_mfma_f32_16x16x32_bf16 v[80:83], a[240:243], v[56:59], v[80:83]
    buffer_load_dwordx4 a[152:155], v3, s[12:15], s78 offen offset:0 sc1
    v_mfma_f32_16x16x32_bf16 v[80:83], a[244:247], v[60:63], v[80:83]
    v_mfma_f32_16x16x32_bf16 v[96:99], a[248:251], v[56:59], v[96:99]
    v_mfma_f32_16x16x32_bf16 v[96:99], a[252:255], v[60:63], v[96:99]
    s_waitcnt lgkmcnt(0)
    s_nop 0
    v_mfma_f32_16x16x32_bf16 v[84:87], a[240:243], v[64:67], v[84:87]
    buffer_load_dwordx4 a[156:159], v3, s[12:15], s78 offen offset:2048 sc1
    s_add_u32 s78, s46, 32768
    v_mfma_f32_16x16x32_bf16 v[84:87], a[244:247], v[68:71], v[84:87]
    v_mfma_f32_16x16x32_bf16 v[100:103], a[248:251], v[64:67], v[100:103]
    v_mfma_f32_16x16x32_bf16 v[100:103], a[252:255], v[68:71], v[100:103]
L_paAjoin:
    s_waitcnt vmcnt(6)
    s_nop 0
    v_mfma_f32_16x16x32_bf16 v[104:107], a[128:131], a[0:3], 0
    buffer_load_dwordx4 a[160:163], v3, s[12:15], s78 offen offset:1024 sc1
    ds_read_b128 v[180:183], v252 offset:6400
    v_mfma_f32_16x16x32_bf16 v[104:107], a[132:135], a[16:19], v[104:107]
    ds_read_b128 v[184:187], v252 offset:6464
    ds_read_b64 v[172:173], v253 offset:6400
    v_mfma_f32_16x16x32_bf16 v[108:111], a[128:131], a[4:7], 0
    ds_read_b64 v[174:175], v253 offset:6464
    v_mfma_f32_16x16x32_bf16 v[108:111], a[132:135], a[20:23], v[108:111]
    v_mfma_f32_16x16x32_bf16 v[112:115], a[128:131], a[8:11], 0
    buffer_load_dwordx4 a[164:167], v3, s[12:15], s78 offen offset:3072 sc1
    s_add_u32 s78, s46, 36864
    v_mfma_f32_16x16x32_bf16 v[112:115], a[132:135], a[24:27], v[112:115]
    v_mfma_f32_16x16x32_bf16 v[116:119], a[128:131], a[12:15], 0
    v_mfma_f32_16x16x32_bf16 v[116:119], a[132:135], a[28:31], v[116:119]
    s_waitcnt vmcnt(6)
    v_mfma_f32_16x16x32_bf16 v[104:107], a[136:139], a[32:35], v[104:107]
    buffer_load_dwordx4 a[168:171], v3, s[12:15], s78 offen offset:1024 sc1
    s_waitcnt lgkmcnt(3)
    v_mul_f32_e64 v72, v72, v180
    v_mfma_f32_16x16x32_bf16 v[104:107], a[140:143], a[48:51], v[104:107]
    v_mul_f32 v73, v73, v181
    v_mul_f32 v74, v74, v182
    v_mfma_f32_16x16x32_bf16 v[108:111], a[136:139], a[36:39], v[108:111]
    v_mul_f32 v75, v75, v183
    v_mul_f32 v76, v76, v180
    v_mfma_f32_16x16x32_bf16 v[108:111], a[140:143], a[52:55], v[108:111]
    v_mul_f32 v77, v77, v181
    v_mul_f32 v78, v78, v182
    v_mfma_f32_16x16x32_bf16 v[112:115], a[136:139], a[40:43], v[112:115]
    buffer_load_dwordx4 a[172:175], v3, s[12:15], s78 offen offset:3072 sc1
    s_add_u32 s78, s46, 40960
    v_mfma_f32_16x16x32_bf16 v[112:115], a[140:143], a[56:59], v[112:115]
    v_mul_f32 v79, v79, v183
    v_mul_f32 v80, v80, v180
    v_mfma_f32_16x16x32_bf16 v[116:119], a[136:139], a[44:47], v[116:119]
    v_mul_f32 v81, v81, v181
    v_mul_f32 v82, v82, v182
    v_mfma_f32_16x16x32_bf16 v[116:119], a[140:143], a[60:63], v[116:119]
    v_mul_f32 v83, v83, v183
    v_mul_f32_e64 v84, v84, v180
    s_waitcnt vmcnt(6)
    v_mfma_f32_16x16x32_bf16 v[104:107], a[144:147], a[64:67], v[104:107]
    buffer_load_dwordx4 a[176:179], v3, s[12:15], s78 offen offset:1024 sc1
    v_mul_f32_e64 v85, v85, v181
    v_mfma_f32_16x16x32_bf16 v[104:107], a[148:151], a[80:83], v[104:107]
    v_mul_f32 v86, v86, v182
    v_mul_f32 v87, v87, v183
    v_mfma_f32_16x16x32_bf16 v[108:111], a[144:147], a[68:71], v[108:111]
    v_sub_f32 v188, 1.0, v180
    v_sub_f32 v189, 1.0, v181
    v_mfma_f32_16x16x32_bf16 v[108:111], a[148:151], a[84:87], v[108:111]
    v_sub_f32 v190, 1.0, v182
    v_sub_f32 v191, 1.0, v183
    v_mfma_f32_16x16x32_bf16 v[112:115], a[144:147], a[72:75], v[112:115]
    buffer_load_dwordx4 a[180:183], v3, s[12:15], s78 offen offset:3072 sc1
    s_add_u32 s78, s46, 45056
    v_mfma_f32_16x16x32_bf16 v[112:115], a[148:151], a[88:91], v[112:115]
    s_waitcnt lgkmcnt(0)
    v_sub_f32 v192, 1.0, v184
    v_mfma_f32_16x16x32_bf16 v[116:119], a[144:147], a[76:79], v[116:119]
    v_sub_f32 v193, 1.0, v185
    v_sub_f32 v194, 1.0, v186
    v_mfma_f32_16x16x32_bf16 v[116:119], a[148:151], a[92:95], v[116:119]
    v_sub_f32 v195, 1.0, v187
    v_mul_f32_e64 v88, v88, v184
    s_waitcnt vmcnt(6)
    v_mfma_f32_16x16x32_bf16 v[104:107], a[152:155], a[96:99], v[104:107]
    buffer_load_dwordx4 a[184:187], v3, s[12:15], s78 offen offset:1024 sc1
    v_mul_f32_e64 v89, v89, v185
    v_mfma_f32_16x16x32_bf16 v[104:107], a[156:159], a[112:115], v[104:107]
    v_mul_f32 v90, v90, v186
    v_mul_f32 v91, v91, v187
    v_mfma_f32_16x16x32_bf16 v[108:111], a[152:155], a[100:103], v[108:111]
    v_mul_f32 v92, v92, v184
    v_mul_f32 v93, v93, v185
    v_mfma_f32_16x16x32_bf16 v[108:111], a[156:159], a[116:119], v[108:111]
    v_mul_f32 v94, v94, v186
    v_mul_f32 v95, v95, v187
    v_mfma_f32_16x16x32_bf16 v[112:115], a[152:155], a[104:107], v[112:115]
    buffer_load_dwordx4 a[188:191], v3, s[12:15], s78 offen offset:3072 sc1
    v_mul_f32_e64 v96, v96, v184
    v_mfma_f32_16x16x32_bf16 v[112:115], a[156:159], a[120:123], v[112:115]
    v_mul_f32 v97, v97, v185
    v_mul_f32 v98, v98, v186
    v_mfma_f32_16x16x32_bf16 v[116:119], a[152:155], a[108:111], v[116:119]
    v_mul_f32 v99, v99, v187
    v_mul_f32 v100, v100, v184
    v_mfma_f32_16x16x32_bf16 v[116:119], a[156:159], a[124:127], v[116:119]
    v_mul_f32 v101, v101, v185
    v_mul_f32_e64 v102, v102, v186
    s_waitcnt vmcnt(6)
    v_mfma_f32_16x16x32_bf16 v[120:123], a[160:163], a[0:3], 0
    v_fmac_f32 v72, v104, v188
    v_fmac_f32 v73, v105, v189
    v_mfma_f32_16x16x32_bf16 v[120:123], a[164:167], a[16:19], v[120:123]
    ds_write_addtid_b32 v72 offset:0
    v_fmac_f32_e64 v74, v106, v190
    v_mfma_f32_16x16x32_bf16 v[124:127], a[160:163], a[4:7], 0
    ds_write_addtid_b32 v73 offset:256
    v_fmac_f32_e64 v75, v107, v191
    v_mfma_f32_16x16x32_bf16 v[124:127], a[164:167], a[20:23], v[124:127]
    ds_write_addtid_b32 v74 offset:512
    v_fmac_f32_e64 v76, v108, v188
    v_mfma_f32_16x16x32_bf16 v[128:131], a[160:163], a[8:11], 0
    ds_write_addtid_b32 v75 offset:768
    v_fmac_f32_e64 v77, v109, v189
    v_mfma_f32_16x16x32_bf16 v[128:131], a[164:167], a[24:27], v[128:131]
    ds_write_addtid_b32 v76 offset:1024
    v_fmac_f32_e64 v78, v110, v190
    v_mfma_f32_16x16x32_bf16 v[132:135], a[160:163], a[12:15], 0
    ds_write_addtid_b32 v77 offset:1280
    v_fmac_f32_e64 v79, v111, v191
    v_mfma_f32_16x16x32_bf16 v[132:135], a[164:167], a[28:31], v[132:135]
    ds_write_addtid_b32 v78 offset:1536
    v_fmac_f32 v80, v112, v188
    s_waitcnt vmcnt(4)
    v_mfma_f32_16x16x32_bf16 v[120:123], a[168:171], a[32:35], v[120:123]
    ds_write_addtid_b32 v79 offset:1792
    v_fmac_f32_e64 v81, v113, v189
    v_mfma_f32_16x16x32_bf16 v[120:123], a[172:175], a[48:51], v[120:123]
    ds_write_addtid_b32 v80 offset:2048
    v_fmac_f32_e64 v82, v114, v190
    v_mfma_f32_16x16x32_bf16 v[124:127], a[168:171], a[36:39], v[124:127]
    ds_write_addtid_b32 v81 offset:2304
    v_fmac_f32_e64 v83, v115, v191
    v_mfma_f32_16x16x32_bf16 v[124:127], a[172:175], a[52:55], v[124:127]
    ds_write_addtid_b32 v82 offset:2560
    v_fmac_f32_e64 v84, v116, v188
    v_mfma_f32_16x16x32_bf16 v[128:131], a[168:171], a[40:43], v[128:131]
    ds_write_addtid_b32 v83 offset:2816
    v_fmac_f32_e64 v85, v117, v189
    v_mfma_f32_16x16x32_bf16 v[128:131], a[172:175], a[56:59], v[128:131]
    ds_write_addtid_b32 v84 offset:3072
    v_fmac_f32_e64 v86, v118, v190
    v_mfma_f32_16x16x32_bf16 v[132:135], a[168:171], a[44:47], v[132:135]
    ds_write_addtid_b32 v85 offset:3328
    v_fmac_f32_e64 v87, v119, v191
    v_mfma_f32_16x16x32_bf16 v[132:135], a[172:175], a[60:63], v[132:135]
    ds_write_addtid_b32 v86 offset:3584
    ds_write_addtid_b32 v87 offset:3840
    s_waitcnt vmcnt(2)
    v_mfma_f32_16x16x32_bf16 v[120:123], a[176:179], a[64:67], v[120:123]
    v_mul_f32 v103, v103, v187
    v_mfma_f32_16x16x32_bf16 v[120:123], a[180:183], a[80:83], v[120:123]
    v_mfma_f32_16x16x32_bf16 v[124:127], a[176:179], a[68:71], v[124:127]
    s_waitcnt lgkmcnt(0)
    s_barrier
    ds_read_b128 v[40:43], v4 offset:0
    ds_read_b128 v[44:47], v4 offset:8192
    ds_read_b128 v[48:51], v4 offset:256
    ds_read_b128 v[52:55], v4 offset:8448
    v_mfma_f32_16x16x32_bf16 v[124:127], a[180:183], a[84:87], v[124:127]
    v_mfma_f32_16x16x32_bf16 v[128:131], a[176:179], a[72:75], v[128:131]
    v_mfma_f32_16x16x32_bf16 v[128:131], a[180:183], a[88:91], v[128:131]
    v_mfma_f32_16x16x32_bf16 v[132:135], a[176:179], a[76:79], v[132:135]
    s_waitcnt lgkmcnt(3)
    v_fma_f32 v144, v172, v144, v40
    v_mfma_f32_16x16x32_bf16 v[132:135], a[180:183], a[92:95], v[132:135]
    v_fma_f32 v145, v172, v145, v41
    v_fma_f32 v146, v172, v146, v42
    s_waitcnt vmcnt(0)
    v_mfma_f32_16x16x32_bf16 v[120:123], a[184:187], a[96:99], v[120:123]
    v_fma_f32 v147, v172, v147, v43
    s_waitcnt lgkmcnt(2)
    v_add_f32 v144, v144, v44
    v_mfma_f32_16x16x32_bf16 v[120:123], a[188:191], a[112:115], v[120:123]
    v_add_f32 v145, v145, v45
    v_add_f32 v146, v146, v46
    v_mfma_f32_16x16x32_bf16 v[124:127], a[184:187], a[100:103], v[124:127]
    v_add_f32_e64 v147, v147, v47
    buffer_store_dwordx4 v[144:147], v179, s[16:19], s81 offen sc1
    v_mfma_f32_16x16x32_bf16 v[124:127], a[188:191], a[116:119], v[124:127]
    s_waitcnt lgkmcnt(0)
    s_nop 0
    v_fma_f32 v148, v173, v148, v48
    v_mfma_f32_16x16x32_bf16 v[128:131], a[184:187], a[104:107], v[128:131]
    v_fma_f32 v149, v173, v149, v49
    v_fma_f32 v150, v173, v150, v50
    v_mfma_f32_16x16x32_bf16 v[128:131], a[188:191], a[120:123], v[128:131]
    v_fma_f32 v151, v173, v151, v51
    v_add_f32_e64 v148, v148, v52
    v_mfma_f32_16x16x32_bf16 v[132:135], a[184:187], a[108:111], v[132:135]
    v_add_f32 v149, v149, v53
    v_add_f32 v150, v150, v54
    v_mfma_f32_16x16x32_bf16 v[132:135], a[188:191], a[124:127], v[132:135]
    v_add_f32_e64 v151, v151, v55
    buffer_store_dwordx4 v[148:151], v16, s[16:19], s81 offen sc1
    v_fmac_f32 v88, v120, v192
    v_fmac_f32 v89, v121, v193
    v_fmac_f32 v90, v122, v194
    v_fmac_f32 v91, v123, v195
    v_pk_fma_f32 v[92:93], v[124:125], v[192:193], v[92:93]
    v_pk_fma_f32 v[94:95], v[126:127], v[194:195], v[94:95]
    v_pk_fma_f32 v[96:97], v[128:129], v[192:193], v[96:97]
    v_pk_fma_f32 v[98:99], v[130:131], v[194:195], v[98:99]
    ds_write_addtid_b32 v88 offset:4096
    ds_write_addtid_b32 v89 offset:4352
    ds_write_addtid_b32 v90 offset:4608
    ds_write_addtid_b32 v91 offset:4864
    ds_write_addtid_b32 v92 offset:5120
    ds_write_addtid_b32 v93 offset:5376
    ds_write_addtid_b32 v94 offset:5632
    ds_write_addtid_b32 v95 offset:5888
    ds_write_addtid_b32 v96 offset:6144
    ds_write_addtid_b32 v97 offset:6400
    ds_write_addtid_b32 v98 offset:6656
    ds_write_addtid_b32 v99 offset:6912
    v_pk_fma_f32 v[100:101], v[132:133], v[192:193], v[100:101]
    v_pk_fma_f32 v[102:103], v[134:135], v[194:195], v[102:103]
    ds_write_addtid_b32 v100 offset:7168
    ds_write_addtid_b32 v101 offset:7424
    ds_write_addtid_b32 v102 offset:7680
    ds_write_addtid_b32 v103 offset:7936
    s_waitcnt lgkmcnt(0)
    s_barrier
    ds_read_b128 v[40:43], v4 offset:4096
    ds_read_b128 v[44:47], v4 offset:12288
    ds_read_b128 v[48:51], v4 offset:4352
    ds_read_b128 v[52:55], v4 offset:12544
    s_waitcnt lgkmcnt(3)
    v_pk_fma_f32 v[152:153], v[174:175], v[152:153], v[40:41] op_sel:[0,0,0] op_sel_hi:[0,1,1]
    v_pk_fma_f32 v[154:155], v[174:175], v[154:155], v[42:43] op_sel:[0,0,0] op_sel_hi:[0,1,1]
    s_waitcnt lgkmcnt(2)
    v_pk_add_f32 v[152:153], v[152:153], v[44:45]
    v_pk_add_f32 v[154:155], v[154:155], v[46:47]
    buffer_store_dwordx4 v[152:155], v179, s[16:19], s74 offen sc1
    s_waitcnt lgkmcnt(1)
    v_pk_fma_f32 v[156:157], v[174:175], v[156:157], v[48:49] op_sel:[1,0,0] op_sel_hi:[1,1,1]
    v_pk_fma_f32 v[158:159], v[174:175], v[158:159], v[50:51] op_sel:[1,0,0] op_sel_hi:[1,1,1]
    s_waitcnt lgkmcnt(0)
    v_pk_add_f32 v[156:157], v[156:157], v[52:53]
    v_pk_add_f32 v[158:159], v[158:159], v[54:55]
    buffer_store_dwordx4 v[156:159], v16, s[16:19], s74 offen sc1
L_end:
    s_endpgm
L_lslowS:
    v_mov_b32 v9, 0
    global_load_dword v9, v9, s[64:65] sc1
    s_add_u32 s86, s86, 1
    s_cmp_gt_u32 s86, 1048576
    s_waitcnt vmcnt(0)
    s_cbranch_scc1 L_lokS
    v_readfirstlane_b32 s56, v9
    s_nop 0
    s_cmp_ge_u32 s56, 32
    s_cbranch_scc0 L_lslowS
    s_branch L_lokS
L_gslowS:
    s_add_u32 s86, s86, 1
    s_cmp_gt_u32 s86, 1048576
    s_cbranch_scc1 L_gokS
    buffer_load_dwordx2 v[232:233], v220, s[32:35], 0 offen sc1
    buffer_load_dwordx2 v[234:235], v221, s[32:35], 0 offen sc1
    buffer_load_dwordx2 v[236:237], v222, s[32:35], 0 offen sc1
    buffer_load_dwordx2 v[238:239], v223, s[32:35], 0 offen sc1
    s_waitcnt vmcnt(0)
    s_branch L_gchkS
L_p0Sslow:
    s_waitcnt vmcnt(16)
    s_nop 0
    ds_read_b64 v[160:161], v12 offset:4096
    ds_read_b64 v[162:163], v12 offset:4224
    ds_read_b64 v[164:165], v12 offset:4352
    ds_read_b64 v[166:167], v12 offset:4480
    ds_read_b64 v[168:169], v13 offset:6144
    s_lshl_b32 s81, s52, 8
    s_add_u32 s74, s81, 4096
    v_add_u32 v16, 32768, v10
    s_waitcnt lgkmcnt(4)
    v_lshlrev_b32_e64 v144, 16, v160
    v_and_b32 v145, 0xffff0000, v160
    v_lshlrev_b32_e64 v146, 16, v161
    v_and_b32 v147, 0xffff0000, v161
    s_waitcnt lgkmcnt(3)
    v_lshlrev_b32 v148, 16, v162
    v_and_b32 v149, 0xffff0000, v162
    v_lshlrev_b32_e64 v150, 16, v163
    v_and_b32 v151, 0xffff0000, v163
    s_waitcnt lgkmcnt(2)
    v_lshlrev_b32 v152, 16, v164
    v_and_b32 v153, 0xffff0000, v164
    v_lshlrev_b32_e64 v154, 16, v165
    v_and_b32 v155, 0xffff0000, v165
    s_waitcnt lgkmcnt(1)
    v_lshlrev_b32 v156, 16, v166
    v_and_b32 v157, 0xffff0000, v166
    v_lshlrev_b32_e64 v158, 16, v167
    v_and_b32 v159, 0xffff0000, v167
    s_waitcnt lgkmcnt(0)
    v_lshlrev_b32 v170, 16, v169
    v_and_b32 v171, 0xffff0000, v169
    v_and_b32 v169, 0xffff0000, v168
    v_lshlrev_b32_e64 v168, 16, v168
    v_pk_mul_f32 v[144:145], v[144:145], v[168:169]
    v_pk_mul_f32 v[146:147], v[146:147], v[170:171]
    v_pk_mul_f32 v[148:149], v[148:149], v[168:169]
    v_pk_mul_f32 v[150:151], v[150:151], v[170:171]
    v_pk_mul_f32 v[152:153], v[152:153], v[168:169]
    v_pk_mul_f32 v[154:155], v[154:155], v[170:171]
    v_pk_mul_f32 v[156:157], v[156:157], v[168:169]
    v_pk_mul_f32 v[158:159], v[158:159], v[170:171]
L_p0Sspin:
    s_mov_b32 s56, 0
    s_atomic_add s56, s[48:49], 0 glc
    s_add_u32 s86, s86, 1
    s_cmp_gt_u32 s86, 1048576
    s_waitcnt lgkmcnt(0)
    s_cbranch_scc1 L_p0Sgo
    s_add_u32 s56, s56, 1
    s_lshr_b32 s57, s56, s59
    s_bitcmp1_b32 s57, 0
    s_cbranch_scc0 L_p0Sspin
L_p0Sgo:
    s_add_u32 s78, s46, 0
    s_nop 0
    buffer_load_dwordx4 a[128:131], v3, s[12:15], s78 offen offset:0 sc1
    buffer_load_dwordx4 a[132:135], v3, s[12:15], s78 offen offset:2048 sc1
    buffer_load_dwordx4 a[136:139], v3, s[12:15], s78 offen offset:1024 sc1
    buffer_load_dwordx4 a[140:143], v3, s[12:15], s78 offen offset:3072 sc1
    s_add_u32 s78, s46, 4096
    buffer_load_dwordx4 a[144:147], v3, s[12:15], s78 offen offset:0 sc1
    buffer_load_dwordx4 a[148:151], v3, s[12:15], s78 offen offset:2048 sc1
    buffer_load_dwordx4 a[152:155], v3, s[12:15], s78 offen offset:1024 sc1
    buffer_load_dwordx4 a[156:159], v3, s[12:15], s78 offen offset:3072 sc1
    s_branch L_p0Sjoin
L_p1Sslow:
    s_waitcnt lgkmcnt(0)
    s_add_u32 s56, s56, 1
    s_lshr_b32 s57, s56, s59
    s_bitcmp1_b32 s57, 1
    s_cbranch_scc1 L_p1Sgo
L_p1Sspin:
    s_mov_b32 s56, 0
    s_atomic_add s56, s[48:49], 0 glc
    s_add_u32 s86, s86, 1
    s_cmp_gt_u32 s86, 1048576
    s_waitcnt lgkmcnt(0)
    s_cbranch_scc1 L_p1Sgo
    s_add_u32 s56, s56, 1
    s_lshr_b32 s57, s56, s59
    s_bitcmp1_b32 s57, 1
    s_cbranch_scc0 L_p1Sspin
L_p1Sgo:
    s_andn2_b32 s56, 15, s57
    s_cbranch_scc0 L_p1Sok
    s_mov_b32 s56, 0
    s_atomic_add s56, s[48:49], 0 glc
    s_branch L_p1Sok
L_p2Sslow:
    s_waitcnt lgkmcnt(0)
    s_add_u32 s56, s56, 1
    s_lshr_b32 s57, s56, s59
    s_bitcmp1_b32 s57, 2
    s_cbranch_scc1 L_p2Sgo
L_p2Sspin:
    s_mov_b32 s56, 0
    s_atomic_add s56, s[48:49], 0 glc
    s_add_u32 s86, s86, 1
    s_cmp_gt_u32 s86, 1048576
    s_waitcnt lgkmcnt(0)
    s_cbranch_scc1 L_p2Sgo
    s_add_u32 s56, s56, 1
    s_lshr_b32 s57, s56, s59
    s_bitcmp1_b32 s57, 2
    s_cbranch_scc0 L_p2Sspin
L_p2Sgo:
    s_andn2_b32 s56, 15, s57
    s_cbranch_scc0 L_p2Sok
    s_mov_b32 s56, 0
    s_atomic_add s56, s[48:49], 0 glc
    s_branch L_p2Sok
L_p3Sslow:
    s_waitcnt lgkmcnt(0)
    s_add_u32 s56, s56, 1
    s_lshr_b32 s57, s56, s59
    s_bitcmp1_b32 s57, 3
    s_cbranch_scc1 L_p3Sgo
L_p3Sspin:
    s_mov_b32 s56, 0
    s_atomic_add s56, s[48:49], 0 glc
    s_add_u32 s86, s86, 1
    s_cmp_gt_u32 s86, 1048576
    s_waitcnt lgkmcnt(0)
    s_cbranch_scc1 L_p3Sgo
    s_add_u32 s56, s56, 1
    s_lshr_b32 s57, s56, s59
    s_bitcmp1_b32 s57, 3
    s_cbranch_scc0 L_p3Sspin
L_p3Sgo:
    s_branch L_p3Sok
L_paSslow:
    s_mov_b32 s56, 0
    s_atomic_add s56, s[48:49], 0 glc
    v_mfma_f32_16x16x32_bf16 v[72:75], a[228:231], v[44:47], v[72:75]
    ds_read_b64 v[66:67], v22 offset:30720
    s_waitcnt vmcnt(4)
    s_nop 0
    v_mfma_f32_16x16x32_bf16 v[88:91], a[232:235], v[40:43], v[88:91]
    ds_read_b64 v[68:69], v23 offset:22528
    v_mfma_f32_16x16x32_bf16 v[88:91], a[236:239], v[44:47], v[88:91]
    ds_read_b64 v[70:71], v23 offset:30720
    v_mfma_f32_16x16x32_bf16 v[76:79], a[224:227], v[48:51], v[76:79]
    ds_read_b64 v[40:41], v24 offset:16384
    v_mfma_f32_16x16x32_bf16 v[76:79], a[228:231], v[52:55], v[76:79]
    ds_read_b64 v[42:43], v24 offset:24576
    v_mfma_f32_16x16x32_bf16 v[92:95], a[232:235], v[48:51], v[92:95]
    ds_read_b64 v[44:45], v25 offset:16384
    v_mfma_f32_16x16x32_bf16 v[92:95], a[236:239], v[52:55], v[92:95]
    ds_read_b64 v[46:47], v25 offset:24576
    v_mfma_f32_16x16x32_bf16 v[80:83], a[224:227], v[56:59], v[80:83]
    ds_read_b64 v[48:49], v24 offset:18432
    v_mfma_f32_16x16x32_bf16 v[80:83], a[228:231], v[60:63], v[80:83]
    ds_read_b64 v[50:51], v24 offset:26624
    v_mfma_f32_16x16x32_bf16 v[96:99], a[232:235], v[56:59], v[96:99]
    ds_read_b64 v[52:53], v25 offset:18432
    v_mfma_f32_16x16x32_bf16 v[96:99], a[236:239], v[60:63], v[96:99]
    ds_read_b64 v[54:55], v25 offset:26624
    s_waitcnt lgkmcnt(8)
    s_nop 0
    v_mfma_f32_16x16x32_bf16 v[84:87], a[224:227], v[64:67], v[84:87]
    ds_read_b64 v[56:57], v24 offset:20480
    v_mfma_f32_16x16x32_bf16 v[84:87], a[228:231], v[68:71], v[84:87]
    ds_read_b64 v[58:59], v24 offset:28672
    v_mfma_f32_16x16x32_bf16 v[100:103], a[232:235], v[64:67], v[100:103]
    ds_read_b64 v[60:61], v25 offset:20480
    v_mfma_f32_16x16x32_bf16 v[100:103], a[236:239], v[68:71], v[100:103]
    ds_read_b64 v[62:63], v25 offset:28672
    s_waitcnt vmcnt(2) lgkmcnt(8)
    v_mfma_f32_16x16x32_bf16 v[72:75], a[240:243], v[40:43], v[72:75]
    ds_read_b64 v[64:65], v24 offset:22528
    v_mfma_f32_16x16x32_bf16 v[72:75], a[244:247], v[44:47], v[72:75]
    ds_read_b64 v[66:67], v24 offset:30720
    s_waitcnt vmcnt(0)
    v_mfma_f32_16x16x32_bf16 v[88:91], a[248:251], v[40:43], v[88:91]
    ds_read_b64 v[68:69], v25 offset:22528
    v_mfma_f32_16x16x32_bf16 v[88:91], a[252:255], v[44:47], v[88:91]
    ds_read_b64 v[70:71], v25 offset:30720
    s_waitcnt lgkmcnt(8)
    v_mfma_f32_16x16x32_bf16 v[76:79], a[240:243], v[48:51], v[76:79]
    v_mfma_f32_16x16x32_bf16 v[76:79], a[244:247], v[52:55], v[76:79]
    v_mfma_f32_16x16x32_bf16 v[92:95], a[248:251], v[48:51], v[92:95]
    v_mfma_f32_16x16x32_bf16 v[92:95], a[252:255], v[52:55], v[92:95]
    s_waitcnt lgkmcnt(4)
    v_mfma_f32_16x16x32_bf16 v[80:83], a[240:243], v[56:59], v[80:83]
    v_mfma_f32_16x16x32_bf16 v[80:83], a[244:247], v[60:63], v[80:83]
    v_mfma_f32_16x16x32_bf16 v[96:99], a[248:251], v[56:59], v[96:99]
    v_mfma_f32_16x16x32_bf16 v[96:99], a[252:255], v[60:63], v[96:99]
    s_waitcnt lgkmcnt(0)
    v_mfma_f32_16x16x32_bf16 v[84:87], a[240:243], v[64:67], v[84:87]
    v_mfma_f32_16x16x32_bf16 v[84:87], a[244:247], v[68:71], v[84:87]
    v_mfma_f32_16x16x32_bf16 v[100:103], a[248:251], v[64:67], v[100:103]
    v_mfma_f32_16x16x32_bf16 v[100:103], a[252:255], v[68:71], v[100:103]
    s_waitcnt lgkmcnt(0)
    s_add_u32 s86, s86, 1
    s_add_u32 s56, s56, 1
    s_and_b32 s56, s56, s61
    s_cmp_eq_u32 s56, s61
    s_cbranch_scc1 L_paSgo
L_paSspin:
    s_mov_b32 s56, 0
    s_atomic_add s56, s[48:49], 0 glc
    s_add_u32 s86, s86, 1
    s_cmp_gt_u32 s86, 1048576
    s_waitcnt lgkmcnt(0)
    s_cbranch_scc1 L_paSgo
    s_add_u32 s56, s56, 1
    s_and_b32 s56, s56, s61
    s_cmp_eq_u32 s56, s61
    s_cbranch_scc0 L_paSspin
L_paSgo:
    s_lshl1_add_u32 m0, s83, 6400
    s_nop 0
    buffer_load_dword v139, s[12:15], s47 offen sc1 lds
    s_lshl_b32 m0, s83, 1
    s_nop 0
    s_add_u32 s78, s46, 32768
    buffer_load_dwordx4 a[128:131], v3, s[12:15], s78 offen offset:0 sc1
    buffer_load_dwordx4 a[132:135], v3, s[12:15], s78 offen offset:2048 sc1
    s_add_u32 s78, s46, 36864
    buffer_load_dwordx4 a[136:139], v3, s[12:15], s78 offen offset:0 sc1
    buffer_load_dwordx4 a[140:143], v3, s[12:15], s78 offen offset:2048 sc1
    s_add_u32 s78, s46, 40960
    buffer_load_dwordx4 a[144:147], v3, s[12:15], s78 offen offset:0 sc1
    buffer_load_dwordx4 a[148:151], v3, s[12:15], s78 offen offset:2048 sc1
    s_add_u32 s78, s46, 45056
    buffer_load_dwordx4 a[152:155], v3, s[12:15], s78 offen offset:0 sc1
    buffer_load_dwordx4 a[156:159], v3, s[12:15], s78 offen offset:2048 sc1
    s_add_u32 s78, s46, 32768
    s_branch L_paSjoin
L_lslowA:
    v_mov_b32 v9, 0
    global_load_dword v9, v9, s[64:65] sc1
    s_add_u32 s86, s86, 1
    s_cmp_gt_u32 s86, 1048576
    s_waitcnt vmcnt(0)
    s_cbranch_scc1 L_lokA
    v_readfirstlane_b32 s56, v9
    s_nop 0
    s_cmp_ge_u32 s56, 32
    s_cbranch_scc0 L_lslowA
    s_branch L_lokA
L_gslowA:
    ds_read_b128 v[244:247], v38 offset:2048
    s_waitcnt lgkmcnt(0)
    v_max3_u32 v6, v244, v245, v246
    v_max_u32 v6, v6, v247
    v_max3_u32 v6, v6, v72, v73
    v_max3_u32 v6, v6, v74, v75
    v_max3_u32 v6, v6, v76, v77
    v_max3_u32 v6, v6, v78, v79
    v_max3_u32 v6, v6, v80, v81
    v_max3_u32 v6, v6, v82, v83
    v_max3_u32 v6, v6, v84, v85
    v_max3_u32 v6, v6, v86, v87
    v_max3_u32 v6, v6, v88, v89
    v_max3_u32 v6, v6, v90, v91
    v_max3_u32 v6, v6, v92, v93
    v_max3_u32 v6, v6, v94, v95
    v_max3_u32 v6, v6, v96, v97
    v_max3_u32 v6, v6, v98, v99
    v_max3_u32 v6, v6, v100, v101
    v_max3_u32 v6, v6, v102, v103
    v_cmp_eq_u32_e64 vcc, -1, v6
    s_cbranch_vccz L_gokA
    s_add_u32 s86, s86, 1
    s_cmp_gt_u32 s86, 1048576
    s_cbranch_scc1 L_gokA
    s_mov_b32 s92, m0
    s_lshl1_add_u32 m0, s83, 2048
    s_nop 0
    buffer_load_dwordx4 v36, s[12:15], s85 offen sc1 lds
    s_mov_b32 m0, s92
    buffer_load_dwordx4 v[72:75], v37, s[12:15], s85 offen offset:0 sc1
    buffer_load_dwordx4 v[76:79], v37, s[12:15], s85 offen offset:1024 sc1
    buffer_load_dwordx4 v[80:83], v37, s[12:15], s85 offen offset:2048 sc1
    buffer_load_dwordx4 v[84:87], v37, s[12:15], s85 offen offset:3072 sc1
    buffer_load_dwordx4 v[88:91], v37, s[12:15], s74 offen offset:0 sc1
    buffer_load_dwordx4 v[92:95], v37, s[12:15], s74 offen offset:1024 sc1
    buffer_load_dwordx4 v[96:99], v37, s[12:15], s74 offen offset:2048 sc1
    buffer_load_dwordx4 v[100:103], v37, s[12:15], s74 offen offset:3072 sc1
    s_waitcnt vmcnt(0)
    ds_read_b64_tr_b16 v[244:245], v38 offset:2048
    ds_read_b64_tr_b16 v[246:247], v38 offset:2056
    s_waitcnt lgkmcnt(0)
    v_mfma_f32_16x16x16_bf16 v[200:203], v[244:245], v[180:181], 0
    v_mfma_f32_16x16x16_bf16 v[204:207], v[246:247], v[180:181], 0
    v_mfma_f32_16x16x16_bf16 v[192:195], v[136:137], v[72:73], 0
    v_mfma_f32_16x16x16_bf16 v[196:199], v[136:137], v[74:75], 0
    v_mfma_f32_16x16x16_bf16 v[192:195], v[136:137], v[76:77], v[192:195]
    v_mfma_f32_16x16x16_bf16 v[196:199], v[136:137], v[78:79], v[196:199]
    v_mfma_f32_16x16x16_bf16 v[192:195], v[136:137], v[80:81], v[192:195]
    v_mfma_f32_16x16x16_bf16 v[196:199], v[136:137], v[82:83], v[196:199]
    v_mfma_f32_16x16x16_bf16 v[192:195], v[136:137], v[84:85], v[192:195]
    v_mfma_f32_16x16x16_bf16 v[196:199], v[136:137], v[86:87], v[196:199]
    v_mfma_f32_16x16x16_bf16 v[192:195], v[136:137], v[88:89], v[192:195]
    v_mfma_f32_16x16x16_bf16 v[196:199], v[136:137], v[90:91], v[196:199]
    v_mfma_f32_16x16x16_bf16 v[192:195], v[136:137], v[92:93], v[192:195]
    v_mfma_f32_16x16x16_bf16 v[196:199], v[136:137], v[94:95], v[196:199]
    v_mfma_f32_16x16x16_bf16 v[192:195], v[136:137], v[96:97], v[192:195]
    v_mfma_f32_16x16x16_bf16 v[196:199], v[136:137], v[98:99], v[196:199]
    v_mfma_f32_16x16x16_bf16 v[192:195], v[136:137], v[100:101], v[192:195]
    v_mfma_f32_16x16x16_bf16 v[196:199], v[136:137], v[102:103], v[196:199]
    s_nop 7
    s_branch L_gchkA
L_p0Aslow:
    ds_read_b64 v[160:161], v32 offset:4096
    ds_read_b64 v[162:163], v32 offset:4224
    ds_read_b64 v[164:165], v32 offset:4352
    ds_read_b64 v[166:167], v32 offset:4480
    ds_read_b64 v[168:169], v33 offset:6144
    s_lshl_b32 s81, s52, 8
    s_add_u32 s74, s81, 4096
    v_add_u32 v16, 32768, v179
    s_waitcnt lgkmcnt(4)
    v_lshlrev_b32_e64 v144, 16, v160
    v_and_b32 v145, 0xffff0000, v160
    v_lshlrev_b32_e64 v146, 16, v161
    v_and_b32 v147, 0xffff0000, v161
    s_waitcnt lgkmcnt(3)
    v_lshlrev_b32 v148, 16, v162
    v_and_b32 v149, 0xffff0000, v162
    v_lshlrev_b32_e64 v150, 16, v163
    v_and_b32 v151, 0xffff0000, v163
    s_waitcnt lgkmcnt(2)
    v_lshlrev_b32 v152, 16, v164
    v_and_b32 v153, 0xffff0000, v164
    v_lshlrev_b32_e64 v154, 16, v165
    v_and_b32 v155, 0xffff0000, v165
    s_waitcnt lgkmcnt(1)
    v_lshlrev_b32 v156, 16, v166
    v_and_b32 v157, 0xffff0000, v166
    v_lshlrev_b32_e64 v158, 16, v167
    v_and_b32 v159, 0xffff0000, v167
    s_waitcnt lgkmcnt(0)
    v_lshlrev_b32 v170, 16, v169
    v_and_b32 v171, 0xffff0000, v169
    v_and_b32 v169, 0xffff0000, v168
    v_lshlrev_b32_e64 v168, 16, v168
    v_pk_mul_f32 v[144:145], v[144:145], v[168:169]
    v_pk_mul_f32 v[146:147], v[146:147], v[170:171]
    v_pk_mul_f32 v[148:149], v[148:149], v[168:169]
    v_pk_mul_f32 v[150:151], v[150:151], v[170:171]
    v_pk_mul_f32 v[152:153], v[152:153], v[168:169]
    v_pk_mul_f32 v[154:155], v[154:155], v[170:171]
    v_pk_mul_f32 v[156:157], v[156:157], v[168:169]
    v_pk_mul_f32 v[158:159], v[158:159], v[170:171]
    s_waitcnt vmcnt(8)
    s_waitcnt vmcnt(0)
    s_barrier
    s_atomic_add s60, s[50:51], 0
    s_atomic_add s60, s[50:51], 128
    s_atomic_add s60, s[50:51], 256
    s_atomic_add s60, s[50:51], 384
L_p0Aspin:
    s_mov_b32 s56, 0
    s_atomic_add s56, s[48:49], 0 glc
    s_add_u32 s86, s86, 1
    s_cmp_gt_u32 s86, 1048576
    s_waitcnt lgkmcnt(0)
    s_cbranch_scc1 L_p0Ago
    s_add_u32 s56, s56, 1
    s_lshr_b32 s57, s56, s59
    s_bitcmp1_b32 s57, 0
    s_cbranch_scc0 L_p0Aspin
L_p0Ago:
    s_add_u32 s78, s46, 0
    buffer_load_dwordx4 a[128:131], v3, s[12:15], s78 offen offset:0 sc1
    buffer_load_dwordx4 a[132:135], v3, s[12:15], s78 offen offset:2048 sc1
    buffer_load_dwordx4 a[136:139], v3, s[12:15], s78 offen offset:1024 sc1
    buffer_load_dwordx4 a[140:143], v3, s[12:15], s78 offen offset:3072 sc1
    s_add_u32 s78, s46, 4096
    buffer_load_dwordx4 a[144:147], v3, s[12:15], s78 offen offset:0 sc1
    buffer_load_dwordx4 a[148:151], v3, s[12:15], s78 offen offset:2048 sc1
    buffer_load_dwordx4 a[152:155], v3, s[12:15], s78 offen offset:1024 sc1
    buffer_load_dwordx4 a[156:159], v3, s[12:15], s78 offen offset:3072 sc1
    s_branch L_p0Ajoin
L_p1Aslow:
    s_waitcnt lgkmcnt(0)
    s_add_u32 s56, s56, 1
    s_lshr_b32 s57, s56, s59
    s_bitcmp1_b32 s57, 1
    s_cbranch_scc1 L_p1Ago
L_p1Aspin:
    s_mov_b32 s56, 0
    s_atomic_add s56, s[48:49], 0 glc
    s_add_u32 s86, s86, 1
    s_cmp_gt_u32 s86, 1048576
    s_waitcnt lgkmcnt(0)
    s_cbranch_scc1 L_p1Ago
    s_add_u32 s56, s56, 1
    s_lshr_b32 s57, s56, s59
    s_bitcmp1_b32 s57, 1
    s_cbranch_scc0 L_p1Aspin
L_p1Ago:
    s_andn2_b32 s56, 15, s57
    s_cbranch_scc0 L_p1Aok
    s_mov_b32 s56, 0
    s_atomic_add s56, s[48:49], 0 glc
    s_branch L_p1Aok
L_p2Aslow:
    s_waitcnt lgkmcnt(0)
    s_add_u32 s56, s56, 1
    s_lshr_b32 s57, s56, s59
    s_bitcmp1_b32 s57, 2
    s_cbranch_scc1 L_p2Ago
L_p2Aspin:
    s_mov_b32 s56, 0
    s_atomic_add s56, s[48:49], 0 glc
    s_add_u32 s86, s86, 1
    s_cmp_gt_u32 s86, 1048576
    s_waitcnt lgkmcnt(0)
    s_cbranch_scc1 L_p2Ago
    s_add_u32 s56, s56, 1
    s_lshr_b32 s57, s56, s59
    s_bitcmp1_b32 s57, 2
    s_cbranch_scc0 L_p2Aspin
L_p2Ago:
    s_andn2_b32 s56, 15, s57
    s_cbranch_scc0 L_p2Aok
    s_mov_b32 s56, 0
    s_atomic_add s56, s[48:49], 0 glc
    s_branch L_p2Aok
L_p3Aslow:
    s_waitcnt lgkmcnt(0)
    s_add_u32 s56, s56, 1
    s_lshr_b32 s57, s56, s59
    s_bitcmp1_b32 s57, 3
    s_cbranch_scc1 L_p3Ago
L_p3Aspin:
    s_mov_b32 s56, 0
    s_atomic_add s56, s[48:49], 0 glc
    s_add_u32 s86, s86, 1
    s_cmp_gt_u32 s86, 1048576
    s_waitcnt lgkmcnt(0)
    s_cbranch_scc1 L_p3Ago
    s_add_u32 s56, s56, 1
    s_lshr_b32 s57, s56, s59
    s_bitcmp1_b32 s57, 3
    s_cbranch_scc0 L_p3Aspin
L_p3Ago:
    s_branch L_p3Aok
L_paAslow:
    s_mov_b32 s56, 0
    s_atomic_add s56, s[48:49], 0 glc
    v_mfma_f32_16x16x32_bf16 v[72:75], a[228:231], v[44:47], v[72:75]
    ds_read_b64 v[66:67], v216 offset:30720
    s_waitcnt vmcnt(4)
    s_nop 0
    v_mfma_f32_16x16x32_bf16 v[88:91], a[232:235], v[40:43], v[88:91]
    ds_read_b64 v[68:69], v217 offset:22528
    v_mfma_f32_16x16x32_bf16 v[88:91], a[236:239], v[44:47], v[88:91]
    ds_read_b64 v[70:71], v217 offset:30720
    v_mfma_f32_16x16x32_bf16 v[76:79], a[224:227], v[48:51], v[76:79]
    ds_read_b64 v[40:41], v218 offset:16384
    v_mfma_f32_16x16x32_bf16 v[76:79], a[228:231], v[52:55], v[76:79]
    ds_read_b64 v[42:43], v218 offset:24576
    v_mfma_f32_16x16x32_bf16 v[92:95], a[232:235], v[48:51], v[92:95]
    ds_read_b64 v[44:45], v219 offset:16384
    v_mfma_f32_16x16x32_bf16 v[92:95], a[236:239], v[52:55], v[92:95]
    ds_read_b64 v[46:47], v219 offset:24576
    v_mfma_f32_16x16x32_bf16 v[80:83], a[224:227], v[56:59], v[80:83]
    ds_read_b64 v[48:49], v218 offset:18432
    v_mfma_f32_16x16x32_bf16 v[80:83], a[228:231], v[60:63], v[80:83]
    ds_read_b64 v[50:51], v218 offset:26624
    v_mfma_f32_16x16x32_bf16 v[96:99], a[232:235], v[56:59], v[96:99]
    ds_read_b64 v[52:53], v219 offset:18432
    v_mfma_f32_16x16x32_bf16 v[96:99], a[236:239], v[60:63], v[96:99]
    ds_read_b64 v[54:55], v219 offset:26624
    s_waitcnt lgkmcnt(8)
    s_nop 0
    v_mfma_f32_16x16x32_bf16 v[84:87], a[224:227], v[64:67], v[84:87]
    ds_read_b64 v[56:57], v218 offset:20480
    v_mfma_f32_16x16x32_bf16 v[84:87], a[228:231], v[68:71], v[84:87]
    ds_read_b64 v[58:59], v218 offset:28672
    v_mfma_f32_16x16x32_bf16 v[100:103], a[232:235], v[64:67], v[100:103]
    ds_read_b64 v[60:61], v219 offset:20480
    v_mfma_f32_16x16x32_bf16 v[100:103], a[236:239], v[68:71], v[100:103]
    ds_read_b64 v[62:63], v219 offset:28672
    s_waitcnt vmcnt(2) lgkmcnt(8)
    v_mfma_f32_16x16x32_bf16 v[72:75], a[240:243], v[40:43], v[72:75]
    ds_read_b64 v[64:65], v218 offset:22528
    v_mfma_f32_16x16x32_bf16 v[72:75], a[244:247], v[44:47], v[72:75]
    ds_read_b64 v[66:67], v218 offset:30720
    s_waitcnt vmcnt(0)
    v_mfma_f32_16x16x32_bf16 v[88:91], a[248:251], v[40:43], v[88:91]
    ds_read_b64 v[68:69], v219 offset:22528
    v_mfma_f32_16x16x32_bf16 v[88:91], a[252:255], v[44:47], v[88:91]
    ds_read_b64 v[70:71], v219 offset:30720
    s_waitcnt lgkmcnt(8)
    v_mfma_f32_16x16x32_bf16 v[76:79], a[240:243], v[48:51], v[76:79]
    v_mfma_f32_16x16x32_bf16 v[76:79], a[244:247], v[52:55], v[76:79]
    v_mfma_f32_16x16x32_bf16 v[92:95], a[248:251], v[48:51], v[92:95]
    v_mfma_f32_16x16x32_bf16 v[92:95], a[252:255], v[52:55], v[92:95]
    s_waitcnt lgkmcnt(4)
    v_mfma_f32_16x16x32_bf16 v[80:83], a[240:243], v[56:59], v[80:83]
    v_mfma_f32_16x16x32_bf16 v[80:83], a[244:247], v[60:63], v[80:83]
    v_mfma_f32_16x16x32_bf16 v[96:99], a[248:251], v[56:59], v[96:99]
    v_mfma_f32_16x16x32_bf16 v[96:99], a[252:255], v[60:63], v[96:99]
    s_waitcnt lgkmcnt(0)
    v_mfma_f32_16x16x32_bf16 v[84:87], a[240:243], v[64:67], v[84:87]
    v_mfma_f32_16x16x32_bf16 v[84:87], a[244:247], v[68:71], v[84:87]
    v_mfma_f32_16x16x32_bf16 v[100:103], a[248:251], v[64:67], v[100:103]
    v_mfma_f32_16x16x32_bf16 v[100:103], a[252:255], v[68:71], v[100:103]
    s_waitcnt lgkmcnt(0)
    s_add_u32 s86, s86, 1
    s_add_u32 s56, s56, 1
    s_and_b32 s56, s56, s61
    s_cmp_eq_u32 s56, s61
    s_cbranch_scc1 L_paAgo
L_paAspin:
    s_mov_b32 s56, 0
    s_atomic_add s56, s[48:49], 0 glc
    s_add_u32 s86, s86, 1
    s_cmp_gt_u32 s86, 1048576
    s_waitcnt lgkmcnt(0)
    s_cbranch_scc1 L_paAgo
    s_add_u32 s56, s56, 1
    s_and_b32 s56, s56, s61
    s_cmp_eq_u32 s56, s61
    s_cbranch_scc0 L_paAspin
L_paAgo:
    s_lshl1_add_u32 m0, s83, 6400
    s_nop 0
    buffer_load_dword v139, s[12:15], s47 offen sc1 lds
    s_lshl_b32 m0, s83, 1
    s_nop 0
    s_add_u32 s78, s46, 32768
    buffer_load_dwordx4 a[128:131], v3, s[12:15], s78 offen offset:0 sc1
    buffer_load_dwordx4 a[132:135], v3, s[12:15], s78 offen offset:2048 sc1
    s_add_u32 s78, s46, 36864
    buffer_load_dwordx4 a[136:139], v3, s[12:15], s78 offen offset:0 sc1
    buffer_load_dwordx4 a[140:143], v3, s[12:15], s78 offen offset:2048 sc1
    s_add_u32 s78, s46, 40960
    buffer_load_dwordx4 a[144:147], v3, s[12:15], s78 offen offset:0 sc1
    buffer_load_dwordx4 a[148:151], v3, s[12:15], s78 offen offset:2048 sc1
    s_add_u32 s78, s46, 45056
    buffer_load_dwordx4 a[152:155], v3, s[12:15], s78 offen offset:0 sc1
    buffer_load_dwordx4 a[156:159], v3, s[12:15], s78 offen offset:2048 sc1
    s_add_u32 s78, s46, 32768
    s_branch L_paAjoin
L_codeend:
.section .rodata,"a"
.p2align 6
.amdhsa_kernel gated_mix__linear_attn_block__ssm_conv_s5__prompt_kernel
  .amdhsa_next_free_vgpr 512
  .amdhsa_next_free_sgpr 102
  .amdhsa_accum_offset 256
  .amdhsa_group_segment_fixed_size 0
  .amdhsa_kernarg_size 128
  .amdhsa_user_sgpr_count 2
  .amdhsa_user_sgpr_kernarg_segment_ptr 1
  .amdhsa_system_sgpr_workgroup_id_x 1
  .amdhsa_float_denorm_mode_32 3
.end_amdhsa_kernel
```
